```python
import torch

def _softmax(x, axis=-1):
    return torch.softmax(x, dim=axis)

def _gelu(x):
    return torch.nn.functional.gelu(x, approximate='tanh')

def _silu(x):
    return torch.nn.functional.silu(x)

def _sigmoid(x):
    return torch.sigmoid(x)

def _layernorm(x, axis=-1, eps=1e-05):
    m = x.mean(dim=axis, keepdim=True)
    v = x.var(dim=axis, keepdim=True, unbiased=False)
    return (x - m) / torch.sqrt(v + eps)

def _scatter_add(tgt, idx, src, axis=0):
    return tgt.clone().index_add_(axis, idx, src)

def _segment_sum(src, seg, n):
    out = torch.zeros((n,) + src.shape[1:], dtype=src.dtype)
    return out.index_add_(0, seg, src)

def _pad(x, pw):
    flat = tuple((v for pair in reversed(pw) for v in pair))
    return torch.nn.functional.pad(x, flat)
kernel_name = 'adaLN_cond__sliding_block_cached__glu_gated_geglu__decode'

def setup_inputs():

    _w = lambda a: (lambda t: t.to(torch.bfloat16) if t.is_floating_point() else t)(torch.as_tensor(a))

    def _A_setup():
        B, Sq, D = (1, 1, 576)
        Hq, Hkv, Sk, Dh = (32, 16, 65536, 128)
        assert Hq % Hkv == 0, (Hq, Hkv)
        return {'x': _w((lambda *s: torch.randn(*s, dtype=torch.bfloat16) * 0.1)(B, Sq, D)), 'k_cache': _w((lambda *s: torch.randn(*s, dtype=torch.bfloat16) * 0.8)(B, Hkv, Sk, Dh)), 'v_cache': _w((lambda *s: torch.randn(*s, dtype=torch.bfloat16) * 3.2)(B, Hkv, Sk, Dh)), 'wq': _w((lambda *s: torch.randn(*s, dtype=torch.bfloat16) * 0.8)(D, Hq * Dh) * D ** (-0.5)), 'wo': _w((lambda *s: torch.randn(*s, dtype=torch.bfloat16) * 3.2)(Hq * Dh, D) * (Hq * Dh) ** (-0.5))}
    _A_in = _A_setup()

    def _B_setup():
        B, S, Dm, Df = (1, 1, 576, 4608)
        return {'x': _w((lambda *s: torch.randn(*s, dtype=torch.bfloat16) * 0.1)(B, S, Dm)), 'w_gate': _w((lambda *s: torch.randn(*s, dtype=torch.bfloat16) * 3.2)(Dm, Df) * Dm ** (-0.5)), 'w_up': _w((lambda *s: torch.randn(*s, dtype=torch.bfloat16) * 3.2)(Dm, Df) * Dm ** (-0.5)), 'w_down': _w((lambda *s: torch.randn(*s, dtype=torch.bfloat16) * 3.2)(Df, Dm) * Df ** (-0.5))}
    _B_in = _B_setup()
    return {'A_x': _A_in['x'], 'A_k_cache': _A_in['k_cache'], 'A_v_cache': _A_in['v_cache'], 'A_wq': _A_in['wq'], 'A_wo': _A_in['wo'], 'B_x': _B_in['x'], 'B_w_gate': _B_in['w_gate'], 'B_w_up': _B_in['w_up'], 'B_w_down': _B_in['w_down'], 'c': _w((lambda *s: torch.randn(*s, dtype=torch.bfloat16) * 0.8)(1, 576) * 8.0), 'w_mod': _w((lambda *s: torch.randn(*s, dtype=torch.bfloat16) * 0.8)(576, 6 * 576) * 576 ** (-0.5) * 8.0)}

def reference(A_x, A_k_cache, A_v_cache, A_wq, A_wo, B_x, B_w_gate, B_w_up, B_w_down, c, w_mod):

    def _A_ref(x, k_cache, v_cache, wq, wo):
        B, Sq, D = x.shape
        Hq, Dh = (32, 128)
        Hkv, Sk = (k_cache.shape[1], k_cache.shape[2])
        W = min(4096, max(256, Sk // 4))
        rep = Hq // Hkv
        q = (lambda x, *d: x.permute(*d))((x @ wq).reshape(B, Sq, Hq, Dh), 0, 2, 1, 3)
        k = (lambda x, n, axis: torch.repeat_interleave(x, n, dim=axis))(k_cache[:, :, Sk - W:, :], rep, axis=1)
        v = (lambda x, n, axis: torch.repeat_interleave(x, n, dim=axis))(v_cache[:, :, Sk - W:, :], rep, axis=1)
        scores = torch.einsum('bhqd,bhkd->bhqk', q, k) * Dh ** (-0.5)
        p = _softmax(scores, axis=-1)
        o = torch.einsum('bhqk,bhkd->bhqd', p, v)
        return (lambda x, *d: x.permute(*d))(o, 0, 2, 1, 3).reshape(B, Sq, Hq * Dh) @ wo

    def _B_ref(x, w_gate, w_up, w_down):
        g = torch.einsum('bsd,df->bsf', x, w_gate)
        u = torch.einsum('bsd,df->bsf', x, w_up)
        h = _gelu(g) * u
        return torch.einsum('bsf,fd->bsd', h, w_down)
    x = A_x
    mod = (_silu(c) @ w_mod).reshape(c.shape[0], 6, 1, -1)
    sa, ca, ga, sb, cb, gb = (mod[:, 0].clone(), mod[:, 1].clone(), mod[:, 2].clone(), mod[:, 3].clone(), mod[:, 4].clone(), mod[:, 5].clone())
    h = _layernorm(x, axis=-1) * (1 + ca) + sa
    x = x + ga * _A_ref(h, A_k_cache, A_v_cache, A_wq, A_wo)
    h = _layernorm(x, axis=-1) * (1 + cb) + sb
    x = x + gb * _B_ref(h, B_w_gate, B_w_up, B_w_down)
    return x
```

```asm
; @launch grid=(256,1,1) block=(1024,1,1) lds=159744
.amdgcn_target "amdgcn-amd-amdhsa--gfx950"
.text
.globl adaLN_cond__sliding_block_cached__glu_gated_geglu__decode_kernel
.p2align 8
.type adaLN_cond__sliding_block_cached__glu_gated_geglu__decode_kernel,@function
adaLN_cond__sliding_block_cached__glu_gated_geglu__decode_kernel:
    s_load_dwordx16 s[16:31], s[0:1], 0
    s_load_dwordx8 s[32:39], s[0:1], 64
    s_load_dwordx2 s[40:41], s[0:1], 104
    s_getpc_b64 s[70:71]
L_pc:
    s_cmp_ge_u32 s2, 256
    s_cbranch_scc1 L_end
    v_lshrrev_b32 v1, 6, v0
    v_and_b32 v0, 63, v0
    s_and_b32 s4, s2, 7
    s_lshr_b32 s5, s2, 3
    v_readfirstlane_b32 s3, v1
    s_and_b32 s54, s5, 15
    s_cmp_lg_u32 s54, s3
    s_cbranch_scc1 L_nopf
    s_lshl_b32 s54, s54, 10
    v_lshl_add_u32 v2, v0, 4, s54
    v_min_u32 v2, L_code_end-L_pc-32, v2
    global_load_dwordx4 v[124:127], v2, s[70:71]
L_nopf:
    s_lshl_b32 s52, s4, 25
    s_lshr_b32 s54, s5, 4
    s_lshl_b32 s54, s54, 24
    s_add_u32 s52, s52, s54
    s_and_b32 s54, s5, 15
    s_lshl_b32 s54, s54, 16
    s_add_u32 s52, s52, s54
    s_add_u32 s43, s52, 0xf00000
    s_mov_b32 s87, 0
    s_waitcnt lgkmcnt(0)
    s_load_dword s42, s[40:41], 0
    s_mov_b32 s44, s40
    s_and_b32 s45, s41, 0xffff
    s_mov_b32 s46, 1073741824
    s_mov_b32 s47, 0x20000
    s_cmp_ge_u32 s3, 8
    s_cbranch_scc1 L_aw
    s_cmp_ge_u32 s3, 4
    s_cbranch_scc1 L_vw
    s_add_u32 s8, s18, s43
    s_addc_u32 s9, s19, 0
    s_and_b32 s9, s9, 0xffff
    s_mov_b32 s10, 65536
    s_mov_b32 s11, 0x20000
    v_lshrrev_b32 v1, 4, v0
    v_and_b32 v2, 15, v0
    v_xor_b32 v3, v1, v2
    v_lshlrev_b32 v3, 4, v3
    v_lshl_add_u32 v4, v1, 8, v3
    v_xor_b32 v5, 64, v4
    s_lshl_b32 s54, s3, 14
    v_xor_b32 v6, 0x80, v4
    v_xor_b32 v7, 0xc0, v4
    s_add_u32 m0, s54, 20480
    s_and_b32 s52, s5, 3
    s_lshl_b32 s52, s52, 2
    s_add_u32 s52, s52, s3
    s_lshl_b32 s52, s52, 12
    buffer_load_dwordx4 v4, s[8:11], s52 offen offset:0 nt lds
    buffer_load_dwordx4 v5, s[8:11], s52 offen offset:1024 nt lds
    buffer_load_dwordx4 v6, s[8:11], s52 offen offset:2048 nt lds
    s_waitcnt lgkmcnt(0)
    s_mul_i32 s7, s42, 0x9e3779b5
    s_add_u32 s7, s7, 0x7f4a7c15
    s_barrier
    s_waitcnt vmcnt(2)
    buffer_load_dwordx4 v7, s[8:11], s52 offen offset:3072 nt lds
    s_addk_i32 s52, 0x4000
    s_addk_i32 m0, 0x1000
    s_and_b32 s52, s52, 0xffff
    s_waitcnt vmcnt(2)
    buffer_load_dwordx4 v4, s[8:11], s52 offen offset:0 nt lds
    s_waitcnt vmcnt(2)
    buffer_load_dwordx4 v5, s[8:11], s52 offen offset:1024 nt lds
    s_waitcnt vmcnt(2)
    buffer_load_dwordx4 v6, s[8:11], s52 offen offset:2048 nt lds
    s_waitcnt vmcnt(2)
    buffer_load_dwordx4 v7, s[8:11], s52 offen offset:3072 nt lds
    s_addk_i32 s52, 0x4000
    s_addk_i32 m0, 0x1000
    s_and_b32 s52, s52, 0xffff
    s_waitcnt vmcnt(2)
    buffer_load_dwordx4 v4, s[8:11], s52 offen offset:0 nt lds
    s_waitcnt vmcnt(2)
    buffer_load_dwordx4 v5, s[8:11], s52 offen offset:1024 nt lds
    s_waitcnt vmcnt(2)
    buffer_load_dwordx4 v6, s[8:11], s52 offen offset:2048 nt lds
    s_waitcnt vmcnt(2)
    buffer_load_dwordx4 v7, s[8:11], s52 offen offset:3072 nt lds
    s_addk_i32 s52, 0x4000
    s_addk_i32 m0, 0x1000
    s_and_b32 s52, s52, 0xffff
    s_waitcnt vmcnt(2)
    buffer_load_dwordx4 v4, s[8:11], s52 offen offset:0 nt lds
    s_waitcnt vmcnt(2)
    buffer_load_dwordx4 v5, s[8:11], s52 offen offset:1024 nt lds
    s_waitcnt vmcnt(2)
    buffer_load_dwordx4 v6, s[8:11], s52 offen offset:2048 nt lds
    s_waitcnt vmcnt(2)
    buffer_load_dwordx4 v7, s[8:11], s52 offen offset:3072 nt lds
    s_lshl_b32 s54, s3, 2
    v_mov_b32 v29, s54
    v_mov_b32 v30, 1
    ds_write_b32 v29, v30 offset:18688
    s_lshl_b32 s54, s3, 14
    s_add_u32 s54, s54, 20480
    v_lshl_add_u32 v4, v2, 8, v3
    v_add_u32 v4, s54, v4
    v_xor_b32 v5, 64, v4
    v_xor_b32 v6, 0x80, v4
    v_xor_b32 v7, 0xc0, v4
    s_lshl_b32 s54, s3, 7
    v_and_b32 v28, 31, v0
    v_lshl_add_u32 v24, v28, 2, s54
    v_and_b32 v25, 1, v0
    v_lshlrev_b32 v25, 8, v25
    v_lshl_add_u32 v25, v1, 4, v25
    s_lshl_b32 s54, s3, 9
    v_and_b32 v26, 3, v0
    v_lshlrev_b32 v26, 6, v26
    v_and_b32 v27, 60, v0
    v_add3_u32 v26, v26, v27, s54
    v_and_b32 v27, 32, v0
    v_lshlrev_b32 v27, 6, v27
    v_lshl_add_u32 v27, v28, 4, v27
    s_lshl_b32 s66, s4, 1
    s_lshr_b32 s55, s5, 4
    s_add_u32 s66, s66, s55
    s_lshl_b32 s67, s66, 12
    s_add_u32 s67, s67, s54
    s_add_u32 s67, s67, 131072
    s_mov_b32 s82, 0xffff0000
    s_mov_b32 s83, 0
    s_mov_b32 s84, 0
    s_mov_b32 s85, 0xffff
    s_mov_b32 s86, 0
    s_mov_b32 s87, 0xffff0000
    s_mov_b32 s88, 0x3fb8aa3b
    s_mov_b32 s53, 0
    buffer_load_dwordx4 v[8:11], v27, s[44:47], s67 offen sc1
    s_waitcnt vmcnt(0)
    ds_read_b128 v[32:35], v4 offset:0
    ds_read_b128 v[36:39], v5 offset:0
    ds_read_b128 v[40:43], v6 offset:0
    ds_read_b128 v[44:47], v7 offset:0
    ds_read_b128 v[48:51], v4 offset:4096
    ds_read_b128 v[52:55], v5 offset:4096
    ds_read_b128 v[56:59], v6 offset:4096
    ds_read_b128 v[60:63], v7 offset:4096
    ds_read_b128 v[64:67], v4 offset:8192
    ds_read_b128 v[68:71], v5 offset:8192
    ds_read_b128 v[72:75], v6 offset:8192
    ds_read_b128 v[76:79], v7 offset:8192
    ds_read_b128 v[80:83], v4 offset:12288
    ds_read_b128 v[84:87], v5 offset:12288
    ds_read_b128 v[88:91], v6 offset:12288
    ds_read_b128 v[92:95], v7 offset:12288
    buffer_load_dwordx4 v[12:15], v27, s[44:47], s67 offen sc1
    s_sleep 7
L_pg_1:
    buffer_load_dwordx4 v[16:19], v27, s[44:47], s67 offen sc1
    s_waitcnt vmcnt(2)
    v_cmp_ne_u32 vcc, s7, v9
    v_cmp_ne_u32_e64 s[56:57], s7, v11
    s_or_b64 vcc, vcc, s[56:57]
    s_cbranch_scc0 L_pgo_3
    buffer_load_dwordx4 v[8:11], v27, s[44:47], s67 offen sc1
    s_waitcnt vmcnt(2)
    v_cmp_ne_u32 vcc, s7, v13
    v_cmp_ne_u32_e64 s[56:57], s7, v15
    s_or_b64 vcc, vcc, s[56:57]
    s_cbranch_scc0 L_pgo_4
    buffer_load_dwordx4 v[12:15], v27, s[44:47], s67 offen sc1
    s_waitcnt vmcnt(2)
    v_cmp_ne_u32 vcc, s7, v17
    v_cmp_ne_u32_e64 s[56:57], s7, v19
    s_or_b64 vcc, vcc, s[56:57]
    s_cbranch_scc0 L_pgo_5
    s_add_u32 s53, s53, 1
    s_cmp_eq_u32 s53, 128
    s_cselect_b32 s54, 524288, 0
    v_add_u32 v27, s54, v27
    s_cmp_lt_u32 s53, 131072
    s_cbranch_scc1 L_pg_1
L_pgo_3:
    v_mov_b32 v4, v8
    v_mov_b32 v5, v10
    v_mov_b32 v6, v8
    v_mov_b32 v7, v10
    s_branch L_pgd_2
L_pgo_4:
    v_mov_b32 v4, v12
    v_mov_b32 v5, v14
    v_mov_b32 v6, v12
    v_mov_b32 v7, v14
    s_branch L_pgd_2
L_pgo_5:
    v_mov_b32 v4, v16
    v_mov_b32 v5, v18
    v_mov_b32 v6, v16
    v_mov_b32 v7, v18
L_pgd_2:
    s_nop 0
    v_permlane32_swap_b32 v4, v6
    v_permlane32_swap_b32 v5, v7
    v_mov_b32 v1, 0
    v_add_f32 v4, v4, v6
    v_add_f32 v5, v5, v7
    v_cvt_pk_bf16_f32 v4, v4, v5
    ds_write_b32 v24, v4 offset:0
    s_mov_b64 exec, 1
    ds_add_u32 v1, v30 offset:18744
    s_mov_b64 exec, -1
    s_mov_b32 s53, 1048576
L_lw_6:
    ds_read_b32 v2, v1 offset:18744
    s_waitcnt lgkmcnt(0)
    v_readfirstlane_b32 s54, v2
    s_cmp_ge_u32 s54, 4
    s_cbranch_scc1 L_lwd_7
    s_sleep 0
    s_sub_u32 s53, s53, 1
    s_cmp_lg_u32 s53, 0
    s_cbranch_scc1 L_lw_6
L_lwd_7:
    ds_read_b128 v[96:99], v25 offset:0
    ds_read_b128 v[100:103], v25 offset:64
    ds_read_b128 v[104:107], v25 offset:128
    ds_read_b128 v[108:111], v25 offset:192
    s_waitcnt lgkmcnt(3)
    v_mfma_f32_16x16x32_bf16 v[112:115], v[96:99], v[32:35], 0
    v_mfma_f32_16x16x32_bf16 v[116:119], v[96:99], v[48:51], 0
    v_mfma_f32_16x16x32_bf16 v[120:123], v[96:99], v[64:67], 0
    v_mfma_f32_16x16x32_bf16 v[124:127], v[96:99], v[80:83], 0
    s_waitcnt lgkmcnt(2)
    v_mfma_f32_16x16x32_bf16 v[112:115], v[100:103], v[36:39], v[112:115]
    v_mfma_f32_16x16x32_bf16 v[116:119], v[100:103], v[52:55], v[116:119]
    v_mfma_f32_16x16x32_bf16 v[120:123], v[100:103], v[68:71], v[120:123]
    v_mfma_f32_16x16x32_bf16 v[124:127], v[100:103], v[84:87], v[124:127]
    s_waitcnt lgkmcnt(1)
    v_mfma_f32_16x16x32_bf16 v[112:115], v[104:107], v[40:43], v[112:115]
    v_mfma_f32_16x16x32_bf16 v[116:119], v[104:107], v[56:59], v[116:119]
    v_mfma_f32_16x16x32_bf16 v[120:123], v[104:107], v[72:75], v[120:123]
    v_mfma_f32_16x16x32_bf16 v[124:127], v[104:107], v[88:91], v[124:127]
    s_waitcnt lgkmcnt(0)
    v_mfma_f32_16x16x32_bf16 v[112:115], v[108:111], v[44:47], v[112:115]
    v_mfma_f32_16x16x32_bf16 v[116:119], v[108:111], v[60:63], v[116:119]
    v_mfma_f32_16x16x32_bf16 v[120:123], v[108:111], v[76:79], v[120:123]
    v_mfma_f32_16x16x32_bf16 v[124:127], v[108:111], v[92:95], v[124:127]
    s_nop 5
    v_cndmask_b32_e64 v32, v112, v116, s[82:83]
    v_cndmask_b32_e64 v33, v113, v117, s[82:83]
    v_cndmask_b32_e64 v32, v32, v120, s[84:85]
    v_cndmask_b32_e64 v33, v33, v121, s[84:85]
    v_cndmask_b32_e64 v32, v32, v124, s[86:87]
    v_cndmask_b32_e64 v33, v33, v125, s[86:87]
    v_cvt_pk_bf16_f32 v32, 0, v32
    v_cvt_pk_bf16_f32 v33, 0, v33
    v_mul_f32 v32, 0x3db504f3, v32
    v_mul_f32 v33, 0x3db504f3, v33
    v_cvt_pk_bf16_f32 v34, 0, v32
    v_cvt_pk_bf16_f32 v35, 0, v33
    v_cvt_pk_bf16_f32 v32, 0, v32
    v_cvt_pk_bf16_f32 v33, 0, v33
    v_max_f32_dpp v34, v34, v34 row_ror:8 row_mask:0xf bank_mask:0xf
    v_max_f32_dpp v35, v35, v35 row_ror:8 row_mask:0xf bank_mask:0xf
    s_nop 0
    v_max_f32_dpp v34, v34, v34 row_ror:4 row_mask:0xf bank_mask:0xf
    v_max_f32_dpp v35, v35, v35 row_ror:4 row_mask:0xf bank_mask:0xf
    s_nop 0
    v_max_f32_dpp v34, v34, v34 row_ror:2 row_mask:0xf bank_mask:0xf
    v_max_f32_dpp v35, v35, v35 row_ror:2 row_mask:0xf bank_mask:0xf
    s_nop 0
    v_max_f32_dpp v34, v34, v34 row_ror:1 row_mask:0xf bank_mask:0xf
    v_max_f32_dpp v35, v35, v35 row_ror:1 row_mask:0xf bank_mask:0xf
    s_nop 0
    v_max_f32_dpp v34, v34, v34 row_bcast:15 row_mask:0xa bank_mask:0xf
    v_max_f32_dpp v35, v35, v35 row_bcast:15 row_mask:0xa bank_mask:0xf
    s_nop 0
    v_max_f32_dpp v34, v34, v34 row_bcast:31 row_mask:0xc bank_mask:0xf
    v_max_f32_dpp v35, v35, v35 row_bcast:31 row_mask:0xc bank_mask:0xf
    v_lshlrev_b32 v36, 1, v29
    v_mov_b32 v1, 0
    s_mov_b32 s58, 0
    s_mov_b32 s59, 0x80000000
    s_mov_b64 exec, s[58:59]
    ds_write_b64 v36, v[34:35] offset:18752
    ds_add_u32 v1, v30 offset:18740
    s_mov_b64 exec, -1
    s_mov_b32 s53, 1048576
L_lw_8:
    ds_read_b32 v2, v1 offset:18740
    s_waitcnt lgkmcnt(0)
    v_readfirstlane_b32 s54, v2
    s_cmp_ge_u32 s54, 4
    s_cbranch_scc1 L_lwd_9
    s_sleep 0
    s_sub_u32 s53, s53, 1
    s_cmp_lg_u32 s53, 0
    s_cbranch_scc1 L_lw_8
L_lwd_9:
    ds_read_b128 v[40:43], v1 offset:18752
    ds_read_b128 v[44:47], v1 offset:18768
    s_waitcnt lgkmcnt(0)
    v_max3_f32 v34, v40, v42, v44
    v_max3_f32 v35, v41, v43, v45
    v_max_f32 v34, v34, v46
    v_max_f32 v35, v35, v47
    v_sub_f32 v37, v32, v34
    v_sub_f32 v38, v33, v35
    v_mul_f32 v37, s88, v37
    v_mul_f32 v38, s88, v38
    v_exp_f32 v37, v37
    v_exp_f32 v38, v38
    v_lshrrev_b32 v36, 16, v34
    v_cvt_pk_bf16_f32 v32, v37, v37
    v_cvt_pk_bf16_f32 v33, v38, v38
    ds_write_b32 v26, v32 offset:2048
    ds_write_b32 v26, v33 offset:2304
    v_or_b32 v36, v36, v35
    v_lshlrev_b32 v39, 2, v29
    v_add_f32_dpp v37, v37, v37 row_ror:8 row_mask:0xf bank_mask:0xf
    v_add_f32_dpp v38, v38, v38 row_ror:8 row_mask:0xf bank_mask:0xf
    s_nop 0
    v_add_f32_dpp v37, v37, v37 row_ror:4 row_mask:0xf bank_mask:0xf
    v_add_f32_dpp v38, v38, v38 row_ror:4 row_mask:0xf bank_mask:0xf
    s_nop 0
    v_add_f32_dpp v37, v37, v37 row_ror:2 row_mask:0xf bank_mask:0xf
    v_add_f32_dpp v38, v38, v38 row_ror:2 row_mask:0xf bank_mask:0xf
    s_nop 0
    v_add_f32_dpp v37, v37, v37 row_ror:1 row_mask:0xf bank_mask:0xf
    v_add_f32_dpp v38, v38, v38 row_ror:1 row_mask:0xf bank_mask:0xf
    s_nop 0
    v_add_f32_dpp v37, v37, v37 row_bcast:15 row_mask:0xa bank_mask:0xf
    v_add_f32_dpp v38, v38, v38 row_bcast:15 row_mask:0xa bank_mask:0xf
    s_nop 0
    v_add_f32_dpp v37, v37, v37 row_bcast:31 row_mask:0xc bank_mask:0xf
    v_add_f32_dpp v38, v38, v38 row_bcast:31 row_mask:0xc bank_mask:0xf
    s_mov_b64 exec, s[58:59]
    ds_write_b96 v39, v[36:38] offset:18816
    ds_write_b32 v29, v30 offset:18704
    s_mov_b64 exec, -1
    s_cmp_lg_u32 s3, 0
    s_cbranch_scc1 L_exit
    s_sub_u32 s54, s5, 27
    s_cmp_lt_u32 s54, 4
    s_cbranch_scc1 L_exit
    s_mov_b32 s6, 8
    s_waitcnt vmcnt(0)
    v_bfe_u32 v2, v0, 1, 1
    v_cmp_eq_u32 vcc, 1, v2
    v_mov_b32 v3, 0xffff
    v_mov_b32 v8, 0xffff0000
    v_cndmask_b32 v3, v3, v8, vcc
    v_bfe_u32 v2, v0, 2, 2
    v_cmp_eq_u32 vcc, 0, v2
    s_nop 1
    v_cndmask_b32 v4, 0, v3, vcc
    v_cmp_eq_u32 vcc, 1, v2
    s_nop 1
    v_cndmask_b32 v5, 0, v3, vcc
    v_cmp_eq_u32 vcc, 2, v2
    s_nop 1
    v_cndmask_b32 v6, 0, v3, vcc
    v_cmp_eq_u32 vcc, 3, v2
    s_nop 1
    v_cndmask_b32 v7, 0, v3, vcc
    v_lshrrev_b32 v28, 4, v0
    v_lshlrev_b32 v28, 3, v28
    v_and_b32 v2, 1, v0
    v_lshl_add_u32 v3, v2, 2, v28
    v_lshlrev_b32 v29, 2, v0
    v_lshlrev_b32 v30, 3, v0
    v_mov_b32 v1, 0
    v_and_b32 v2, 7, v0
    v_lshl_add_u32 v28, v2, 5, v28
    s_lshl_b32 s54, s6, 8
    v_add_u32 v28, s54, v28
    s_mov_b32 s60, 0x00ff00ff
    s_mov_b32 s61, 0x00ff00ff
    s_cmp_eq_u32 s5, 31
    s_cbranch_scc1 L_ln
    s_cmp_ge_u32 s5, 9
    s_cbranch_scc1 L_gu_post
    s_branch L_wd_9
L_vw:
    s_sub_u32 s3, s3, 4
L_vw_setup:
    v_lshlrev_b32 v27, 4, v0
    s_add_u32 s8, s20, s43
    s_addc_u32 s9, s21, 0
    s_and_b32 s9, s9, 0xffff
    s_mov_b32 s10, 65536
    s_mov_b32 s11, 0x20000
    s_and_b32 s52, s5, 3
    s_lshl_b32 s52, s52, 2
    s_add_u32 s52, s52, s3
    s_lshl_b32 s52, s52, 12
    v_bfe_u32 v2, v0, 0, 1
    v_cmp_eq_u32 vcc, 1, v2
    v_mov_b32 v3, 0xffff
    v_mov_b32 v8, 0xffff0000
    v_cndmask_b32 v3, v3, v8, vcc
    v_bfe_u32 v2, v0, 1, 2
    v_cmp_eq_u32 vcc, 0, v2
    s_nop 1
    v_cndmask_b32 v4, 0, v3, vcc
    v_cmp_eq_u32 vcc, 1, v2
    s_nop 1
    v_cndmask_b32 v5, 0, v3, vcc
    v_cmp_eq_u32 vcc, 2, v2
    s_nop 1
    v_cndmask_b32 v6, 0, v3, vcc
    v_cmp_eq_u32 vcc, 3, v2
    s_nop 1
    v_cndmask_b32 v7, 0, v3, vcc
    s_mov_b32 s62, 0x07060501
    s_mov_b32 s63, 0x07060502
    s_mov_b32 s64, 0x07060503
    s_mov_b32 s65, 0x0c04000c
    s_lshl_b32 s54, s3, 2
    v_mov_b32 v29, s54
    v_mov_b32 v1, 0
    v_bfe_u32 v2, v0, 3, 1
    v_lshlrev_b32 v28, 8, v2
    v_and_b32 v3, 48, v0
    v_lshl_add_u32 v28, v3, 2, v28
    s_lshl_b32 s54, s3, 9
    v_add_u32 v28, s54, v28
    v_and_b32 v3, 32, v0
    v_lshl_add_u32 v30, v2, 4, v3
    v_and_b32 v3, 7, v0
    v_lshl_add_u32 v30, v3, 1, v30
    v_bfe_u32 v3, v0, 4, 1
    v_add_u32 v30, v30, v3
    v_lshlrev_b32 v30, 4, v30
    s_lshl_b32 s54, s3, 10
    v_add_u32 v30, s54, v30
    s_lshl_b32 s66, s4, 5
    s_add_u32 s66, s66, s5
    s_lshl_b32 s68, s66, 7
    s_add_u32 s68, s68, 196608
    s_lshl_b32 s66, s66, 10
    s_add_u32 s66, s66, 360448
    s_waitcnt lgkmcnt(0)
    s_mul_i32 s7, s42, 0x9e3779b5
    s_add_u32 s7, s7, 0x7f4a7c15
    s_barrier
    s_cmp_lg_u32 s3, 0
    s_cbranch_scc1 L_vw_nopw
    buffer_load_dwordx4 v[8:11], v27, s[44:47], s66 offen nt
    s_mov_b64 exec, 0xff
    buffer_load_dwordx4 v[8:11], v27, s[44:47], s68 offen nt
    s_mov_b64 exec, -1
    s_xor_b32 s54, s7, 1
    v_mov_b32 v15, s54
    buffer_store_dwordx4 v[12:15], v27, s[44:47], s66 offen
    s_mov_b64 exec, 0xff
    buffer_store_dwordx4 v[12:15], v27, s[44:47], s68 offen
    s_mov_b64 exec, -1
L_vw_nopw:
    s_mov_b32 s53, 1048576
L_lw_10:
    ds_read_b32 v2, v29 offset:18688
    s_waitcnt lgkmcnt(0)
    v_readfirstlane_b32 s54, v2
    s_cmp_ge_u32 s54, 1
    s_cbranch_scc1 L_lwd_11
    s_sleep 1
    s_sub_u32 s53, s53, 1
    s_cmp_lg_u32 s53, 0
    s_cbranch_scc1 L_lw_10
L_lwd_11:
    buffer_load_dwordx4 v[32:35], v27, s[8:11], s52 offen offset:0 nt
    buffer_load_dwordx4 v[36:39], v27, s[8:11], s52 offen offset:1024 nt
    buffer_load_dwordx4 v[40:43], v27, s[8:11], s52 offen offset:2048 nt
    buffer_load_dwordx4 v[44:47], v27, s[8:11], s52 offen offset:3072 nt
    s_addk_i32 s52, 0x4000
    s_and_b32 s52, s52, 0xffff
    s_waitcnt vmcnt(3)
    buffer_load_dwordx4 v[48:51], v27, s[8:11], s52 offen offset:0 nt
    s_waitcnt vmcnt(3)
    buffer_load_dwordx4 v[52:55], v27, s[8:11], s52 offen offset:1024 nt
    s_waitcnt vmcnt(3)
    buffer_load_dwordx4 v[56:59], v27, s[8:11], s52 offen offset:2048 nt
    s_waitcnt vmcnt(3)
    buffer_load_dwordx4 v[60:63], v27, s[8:11], s52 offen offset:3072 nt
    s_addk_i32 s52, 0x4000
    s_and_b32 s52, s52, 0xffff
    s_waitcnt vmcnt(3)
    buffer_load_dwordx4 v[64:67], v27, s[8:11], s52 offen offset:0 nt
    s_waitcnt vmcnt(3)
    buffer_load_dwordx4 v[68:71], v27, s[8:11], s52 offen offset:1024 nt
    s_waitcnt vmcnt(3)
    buffer_load_dwordx4 v[72:75], v27, s[8:11], s52 offen offset:2048 nt
    s_waitcnt vmcnt(3)
    buffer_load_dwordx4 v[76:79], v27, s[8:11], s52 offen offset:3072 nt
    s_addk_i32 s52, 0x4000
    s_and_b32 s52, s52, 0xffff
    s_waitcnt vmcnt(3)
    buffer_load_dwordx4 v[80:83], v27, s[8:11], s52 offen offset:0 nt
    s_waitcnt vmcnt(3)
    buffer_load_dwordx4 v[84:87], v27, s[8:11], s52 offen offset:1024 nt
    s_waitcnt vmcnt(3)
    buffer_load_dwordx4 v[88:91], v27, s[8:11], s52 offen offset:2048 nt
    s_waitcnt vmcnt(3)
    buffer_load_dwordx4 v[92:95], v27, s[8:11], s52 offen offset:3072 nt
    v_mov_b32 v2, 1
    s_mov_b64 exec, 1
    ds_add_u32 v1, v2 offset:18720
    s_mov_b64 exec, -1
    s_mov_b32 s53, 1048576
L_lw_12:
    ds_read_b32 v2, v29 offset:18704
    s_waitcnt lgkmcnt(0)
    v_readfirstlane_b32 s54, v2
    s_cmp_ge_u32 s54, 1
    s_cbranch_scc1 L_lwd_13
    s_sleep 1
    s_sub_u32 s53, s53, 1
    s_cmp_lg_u32 s53, 0
    s_cbranch_scc1 L_lw_12
L_lwd_13:
    ds_read_b128 v[8:11], v28 offset:2048
    ds_read_b128 v[12:15], v28 offset:2064
    ds_read_b128 v[16:19], v28 offset:2080
    ds_read_b128 v[20:23], v28 offset:2096
    s_waitcnt lgkmcnt(3)
    v_and_b32 v96, v8, v4
    v_and_b32 v97, v8, v5
    v_and_b32 v98, v8, v6
    v_and_b32 v99, v8, v7
    v_and_b32 v100, v9, v4
    v_and_b32 v101, v9, v5
    v_and_b32 v102, v9, v6
    v_and_b32 v103, v9, v7
    v_mov_b32 v3, v27
    v_mfma_f32_16x16x32_bf16 v[24:27], v[96:99], v[32:35], 0
    v_and_b32 v104, v10, v4
    v_and_b32 v105, v10, v5
    v_and_b32 v106, v10, v6
    v_and_b32 v107, v10, v7
    v_mfma_f32_16x16x32_bf16 v[24:27], v[100:103], v[36:39], v[24:27]
    v_and_b32 v108, v11, v4
    v_and_b32 v109, v11, v5
    v_and_b32 v110, v11, v6
    v_and_b32 v111, v11, v7
    v_mfma_f32_16x16x32_bf16 v[24:27], v[104:107], v[40:43], v[24:27]
    s_waitcnt lgkmcnt(2)
    v_and_b32 v112, v12, v4
    v_and_b32 v113, v12, v5
    v_and_b32 v114, v12, v6
    v_and_b32 v115, v12, v7
    v_mfma_f32_16x16x32_bf16 v[24:27], v[108:111], v[44:47], v[24:27]
    v_and_b32 v116, v13, v4
    v_and_b32 v117, v13, v5
    v_and_b32 v118, v13, v6
    v_and_b32 v119, v13, v7
    v_mfma_f32_16x16x32_bf16 v[24:27], v[112:115], v[48:51], v[24:27]
    v_and_b32 v120, v14, v4
    v_and_b32 v121, v14, v5
    v_and_b32 v122, v14, v6
    v_and_b32 v123, v14, v7
    v_mfma_f32_16x16x32_bf16 v[24:27], v[116:119], v[52:55], v[24:27]
    v_and_b32 v124, v15, v4
    v_and_b32 v125, v15, v5
    v_and_b32 v126, v15, v6
    v_and_b32 v127, v15, v7
    v_mfma_f32_16x16x32_bf16 v[24:27], v[120:123], v[56:59], v[24:27]
    s_waitcnt lgkmcnt(1)
    v_and_b32 v96, v16, v4
    v_and_b32 v97, v16, v5
    v_and_b32 v98, v16, v6
    v_and_b32 v99, v16, v7
    v_mfma_f32_16x16x32_bf16 v[24:27], v[124:127], v[60:63], v[24:27]
    v_and_b32 v100, v17, v4
    v_and_b32 v101, v17, v5
    v_and_b32 v102, v17, v6
    v_and_b32 v103, v17, v7
    v_mfma_f32_16x16x32_bf16 v[24:27], v[96:99], v[64:67], v[24:27]
    v_and_b32 v104, v18, v4
    v_and_b32 v105, v18, v5
    v_and_b32 v106, v18, v6
    v_and_b32 v107, v18, v7
    v_mfma_f32_16x16x32_bf16 v[24:27], v[100:103], v[68:71], v[24:27]
    v_and_b32 v108, v19, v4
    v_and_b32 v109, v19, v5
    v_and_b32 v110, v19, v6
    v_and_b32 v111, v19, v7
    v_mfma_f32_16x16x32_bf16 v[24:27], v[104:107], v[72:75], v[24:27]
    s_waitcnt lgkmcnt(0)
    v_and_b32 v112, v20, v4
    v_and_b32 v113, v20, v5
    v_and_b32 v114, v20, v6
    v_and_b32 v115, v20, v7
    v_mfma_f32_16x16x32_bf16 v[24:27], v[108:111], v[76:79], v[24:27]
    v_and_b32 v116, v21, v4
    v_and_b32 v117, v21, v5
    v_and_b32 v118, v21, v6
    v_and_b32 v119, v21, v7
    s_waitcnt vmcnt(3)
    v_mfma_f32_16x16x32_bf16 v[24:27], v[112:115], v[80:83], v[24:27]
    v_and_b32 v120, v22, v4
    v_and_b32 v121, v22, v5
    v_and_b32 v122, v22, v6
    v_and_b32 v123, v22, v7
    s_waitcnt vmcnt(2)
    v_mfma_f32_16x16x32_bf16 v[24:27], v[116:119], v[84:87], v[24:27]
    v_and_b32 v124, v23, v4
    v_and_b32 v125, v23, v5
    v_and_b32 v126, v23, v6
    v_and_b32 v127, v23, v7
    s_waitcnt vmcnt(1)
    v_mfma_f32_16x16x32_bf16 v[24:27], v[120:123], v[88:91], v[24:27]
    s_waitcnt vmcnt(0)
    v_mfma_f32_16x16x32_bf16 v[24:27], v[124:127], v[92:95], v[24:27]
    v_mov_b32 v2, 1
    s_nop 6
    ds_write_b128 v30, v[24:27] offset:4096
    s_mov_b64 exec, 1
    ds_add_rtn_u32 v2, v1, v2 offset:18724
    s_mov_b64 exec, -1
    ds_read_b128 v[8:11], v3 offset:4096
    ds_read_b128 v[12:15], v3 offset:5120
    ds_read_b128 v[16:19], v3 offset:6144
    ds_read_b128 v[20:23], v3 offset:7168
    ds_read_b128 v[32:35], v1 offset:18816
    ds_read_b128 v[36:39], v1 offset:18832
    ds_read_b128 v[40:43], v1 offset:18848
    ds_read_b128 v[44:47], v1 offset:18864
    s_waitcnt lgkmcnt(8)
    v_readfirstlane_b32 s54, v2
    s_cmp_lg_u32 s54, 3
    s_cbranch_scc1 L_exit
    s_waitcnt lgkmcnt(6)
    v_add_f32 v8, v8, v12
    v_add_f32 v9, v9, v13
    v_add_f32 v10, v10, v14
    v_add_f32 v11, v11, v15
    s_waitcnt lgkmcnt(5)
    v_add_f32 v8, v8, v16
    v_add_f32 v9, v9, v17
    v_add_f32 v10, v10, v18
    v_add_f32 v11, v11, v19
    s_waitcnt lgkmcnt(4)
    v_add_f32 v8, v8, v20
    v_add_f32 v9, v9, v21
    v_add_f32 v10, v10, v22
    v_add_f32 v11, v11, v23
    v_perm_b32 v8, v8, v11, s62
    v_perm_b32 v9, v9, v11, s63
    v_perm_b32 v10, v10, v11, s64
    v_mov_b32 v11, s7
    buffer_store_dwordx4 v[8:11], v3, s[44:47], s66 offen
    s_waitcnt lgkmcnt(0)
    v_add_f32 v33, v33, v37
    v_add_f32 v34, v34, v38
    v_add_f32 v41, v41, v45
    v_add_f32 v42, v42, v46
    v_mov_b32 v35, s7
    v_add_f32 v33, v33, v41
    v_add_f32 v34, v34, v42
    s_mov_b64 exec, 0xff
    buffer_store_dwordx4 v[32:35], v3, s[44:47], s68 offen
    s_mov_b64 exec, -1
    v_mov_b32 v2, 1
    ds_write_b32 v1, v2 offset:18736
    s_cmp_ge_u32 s5, 9
    s_cbranch_scc1 L_vw_slow
    s_mov_b32 s53, 48
L_lw_14:
    ds_read_b32 v2, v1 offset:18748
    s_waitcnt lgkmcnt(0)
    v_readfirstlane_b32 s54, v2
    s_cmp_ge_u32 s54, 1
    s_cbranch_scc1 L_lwd_15
    s_sleep 2
    s_sub_u32 s53, s53, 1
    s_cmp_lg_u32 s53, 0
    s_cbranch_scc1 L_lw_14
L_lwd_15:
L_vw_slow:
    s_add_u32 s68, s68, 524288
    s_add_u32 s66, s66, 524288
    buffer_store_dwordx4 v[8:11], v3, s[44:47], s66 offen sc1
    s_mov_b64 exec, 0xff
    buffer_store_dwordx4 v[32:35], v3, s[44:47], s68 offen sc1
    s_mov_b64 exec, -1
    s_branch L_exit
L_aw:
    s_sub_u32 s6, s3, 8
    s_cmp_lt_u32 s5, 9
    s_cbranch_scc1 L_wd
    s_cmp_lt_u32 s5, 25
    s_cbranch_scc1 L_q
    s_mul_i32 s66, s4, 7
    s_add_u32 s66, s66, s5
    s_sub_u32 s66, s66, 25
L_a_job:
    s_mul_i32 s67, s66, 0x5556
    s_lshr_b32 s67, s67, 16
    s_mul_i32 s54, s67, 3
    s_sub_u32 s68, s66, s54
    s_mul_i32 s69, s68, 3
    s_add_u32 s69, s69, s6
    s_mov_b32 s8, s36
    s_and_b32 s9, s37, 0xffff
    s_mov_b32 s10, 3981312
    s_mov_b32 s11, 0x20000
    s_mov_b32 s48, s34
    s_and_b32 s49, s35, 0xffff
    s_mov_b32 s50, 1152
    s_mov_b32 s51, 0x20000
    v_lshrrev_b32 v26, 3, v0
    v_mul_u32_u24 v26, 6912, v26
    v_and_b32 v2, 7, v0
    v_lshl_add_u32 v26, v2, 4, v26
    s_cmp_lt_u32 s66, 54
    s_cselect_b32 s55, s6, 7
    s_cmp_ge_u32 s55, 3
    s_cbranch_scc1 L_a_skip
    s_mul_i32 s52, s69, 442368
    s_lshl_b32 s54, s67, 7
    s_add_u32 s52, s52, s54
    s_lshl_b32 s54, s69, 7
    v_lshlrev_b32 v2, 1, v0
    buffer_load_ushort v25, v2, s[48:51], s54 offen
    buffer_load_dwordx4 v[32:35], v26, s[8:11], s52 offen nt
    s_add_u32 s52, s52, 55296
    buffer_load_dwordx4 v[36:39], v26, s[8:11], s52 offen nt
    s_add_u32 s52, s52, 55296
    buffer_load_dwordx4 v[40:43], v26, s[8:11], s52 offen nt
    s_add_u32 s52, s52, 55296
    buffer_load_dwordx4 v[44:47], v26, s[8:11], s52 offen nt
    s_add_u32 s52, s52, 55296
    buffer_load_dwordx4 v[48:51], v26, s[8:11], s52 offen nt
    s_add_u32 s52, s52, 55296
    buffer_load_dwordx4 v[52:55], v26, s[8:11], s52 offen nt
    s_add_u32 s52, s52, 55296
    buffer_load_dwordx4 v[56:59], v26, s[8:11], s52 offen nt
    s_add_u32 s52, s52, 55296
    buffer_load_dwordx4 v[60:63], v26, s[8:11], s52 offen nt
    v_bfe_u32 v2, v0, 1, 1
    v_cmp_eq_u32 vcc, 1, v2
    v_mov_b32 v3, 0xffff
    v_mov_b32 v8, 0xffff0000
    v_cndmask_b32 v3, v3, v8, vcc
    v_bfe_u32 v2, v0, 2, 2
    v_cmp_eq_u32 vcc, 0, v2
    s_nop 1
    v_cndmask_b32 v4, 0, v3, vcc
    v_cmp_eq_u32 vcc, 1, v2
    s_nop 1
    v_cndmask_b32 v5, 0, v3, vcc
    v_cmp_eq_u32 vcc, 2, v2
    s_nop 1
    v_cndmask_b32 v6, 0, v3, vcc
    v_cmp_eq_u32 vcc, 3, v2
    s_nop 1
    v_cndmask_b32 v7, 0, v3, vcc
    v_lshrrev_b32 v28, 4, v0
    v_lshlrev_b32 v28, 3, v28
    v_and_b32 v2, 1, v0
    v_lshl_add_u32 v3, v2, 2, v28
    v_lshlrev_b32 v29, 2, v0
    v_lshlrev_b32 v30, 3, v0
    v_mov_b32 v1, 0
    v_and_b32 v2, 7, v0
    v_lshl_add_u32 v28, v2, 5, v28
    s_lshl_b32 s54, s6, 8
    v_add_u32 v28, s54, v28
    s_mov_b32 s60, 0x00ff00ff
    s_mov_b32 s61, 0x00ff00ff
    s_waitcnt lgkmcnt(0)
    s_mul_i32 s7, s42, 0x9e3779b5
    s_add_u32 s7, s7, 0x7f4a7c15
    s_barrier
    s_mul_i32 s52, s68, 9216
    s_lshl_b32 s54, s67, 9
    s_add_u32 s52, s52, s54
    s_add_u32 s52, s52, 4096
    s_waitcnt vmcnt(8)
    v_lshlrev_b32 v25, 16, v25
    v_max_f32 v25, 0xc3000000, v25
    v_mul_f32 v2, 0xbfb8aa3b, v25
    v_exp_f32 v2, v2
    s_nop 0
    v_add_f32 v2, 1.0, v2
    v_min_f32 v2, 0x7e800000, v2
    v_rcp_f32 v8, v2
    s_nop 0
    v_mul_f32 v9, v25, v8
    v_fma_f32 v25, -v9, v2, v25
    v_fma_f32 v25, v25, v8, v9
    v_cvt_pk_bf16_f32 v25, v25, v25
    ds_bpermute_b32 v8, v3, v25 offset:0
    ds_bpermute_b32 v9, v3, v25 offset:32
    ds_bpermute_b32 v10, v3, v25 offset:64
    ds_bpermute_b32 v11, v3, v25 offset:96
    ds_bpermute_b32 v12, v3, v25 offset:128
    ds_bpermute_b32 v13, v3, v25 offset:160
    ds_bpermute_b32 v14, v3, v25 offset:192
    ds_bpermute_b32 v15, v3, v25 offset:224
    s_waitcnt lgkmcnt(7)
    v_and_b32 v96, v8, v4
    v_and_b32 v97, v8, v5
    v_and_b32 v98, v8, v6
    v_and_b32 v99, v8, v7
    s_waitcnt lgkmcnt(6)
    v_and_b32 v100, v9, v4
    v_and_b32 v101, v9, v5
    v_and_b32 v102, v9, v6
    v_and_b32 v103, v9, v7
    s_waitcnt lgkmcnt(5)
    v_and_b32 v104, v10, v4
    v_and_b32 v105, v10, v5
    v_and_b32 v106, v10, v6
    v_and_b32 v107, v10, v7
    s_waitcnt lgkmcnt(4)
    v_and_b32 v108, v11, v4
    v_and_b32 v109, v11, v5
    v_and_b32 v110, v11, v6
    v_and_b32 v111, v11, v7
    s_waitcnt lgkmcnt(3)
    v_and_b32 v112, v12, v4
    v_and_b32 v113, v12, v5
    v_and_b32 v114, v12, v6
    v_and_b32 v115, v12, v7
    s_waitcnt lgkmcnt(2)
    v_and_b32 v116, v13, v4
    v_and_b32 v117, v13, v5
    v_and_b32 v118, v13, v6
    v_and_b32 v119, v13, v7
    s_waitcnt lgkmcnt(1)
    v_and_b32 v120, v14, v4
    v_and_b32 v121, v14, v5
    v_and_b32 v122, v14, v6
    v_and_b32 v123, v14, v7
    s_waitcnt lgkmcnt(0)
    v_and_b32 v124, v15, v4
    v_and_b32 v125, v15, v5
    v_and_b32 v126, v15, v6
    v_and_b32 v127, v15, v7
    s_waitcnt vmcnt(7)
    v_mfma_f32_16x16x32_bf16 v[24:27], v[96:99], v[32:35], 0
    s_waitcnt vmcnt(6)
    v_mfma_f32_16x16x32_bf16 v[24:27], v[100:103], v[36:39], v[24:27]
    s_waitcnt vmcnt(5)
    v_mfma_f32_16x16x32_bf16 v[24:27], v[104:107], v[40:43], v[24:27]
    s_waitcnt vmcnt(4)
    v_mfma_f32_16x16x32_bf16 v[24:27], v[108:111], v[44:47], v[24:27]
    s_waitcnt vmcnt(3)
    v_mfma_f32_16x16x32_bf16 v[24:27], v[112:115], v[48:51], v[24:27]
    s_waitcnt vmcnt(2)
    v_mfma_f32_16x16x32_bf16 v[24:27], v[116:119], v[52:55], v[24:27]
    s_waitcnt vmcnt(1)
    v_mfma_f32_16x16x32_bf16 v[24:27], v[120:123], v[56:59], v[24:27]
    s_waitcnt vmcnt(0)
    v_mfma_f32_16x16x32_bf16 v[24:27], v[124:127], v[60:63], v[24:27]
    v_mov_b32 v2, 1
    s_nop 6
    v_add_f32_dpp v24, v25, v24 row_ror:8 row_mask:0xf bank_mask:0xf
    v_add_f32_dpp v25, v27, v26 row_ror:8 row_mask:0xf bank_mask:0xf
    s_mov_b64 exec, s[60:61]
    ds_write_b64 v28, v[24:25] offset:18944
    s_mov_b64 exec, 1
    ds_add_rtn_u32 v2, v1, v2 offset:18892
    s_mov_b64 exec, -1
    ds_read2st64_b32 v[104:105], v29 offset0:74 offset1:75
    ds_read_b32 v106, v29 offset:19456
    s_waitcnt lgkmcnt(2)
    v_readfirstlane_b32 s54, v2
    s_cmp_lg_u32 s54, 2
    s_cbranch_scc1 L_a_done
    s_waitcnt lgkmcnt(1)
    v_add_f32 v8, v104, v105
    s_waitcnt lgkmcnt(0)
    v_add_f32 v8, v8, v106
    v_mov_b32 v9, s7
    buffer_store_dwordx2 v[8:9], v30, s[44:47], s52 offen sc1
    v_mov_b32 v2, 1
    ds_write_b32 v1, v2 offset:18880
    s_branch L_a_done
L_a_skip:
    v_bfe_u32 v2, v0, 1, 1
    v_cmp_eq_u32 vcc, 1, v2
    v_mov_b32 v3, 0xffff
    v_mov_b32 v8, 0xffff0000
    v_cndmask_b32 v3, v3, v8, vcc
    v_bfe_u32 v2, v0, 2, 2
    v_cmp_eq_u32 vcc, 0, v2
    s_nop 1
    v_cndmask_b32 v4, 0, v3, vcc
    v_cmp_eq_u32 vcc, 1, v2
    s_nop 1
    v_cndmask_b32 v5, 0, v3, vcc
    v_cmp_eq_u32 vcc, 2, v2
    s_nop 1
    v_cndmask_b32 v6, 0, v3, vcc
    v_cmp_eq_u32 vcc, 3, v2
    s_nop 1
    v_cndmask_b32 v7, 0, v3, vcc
    v_lshrrev_b32 v28, 4, v0
    v_lshlrev_b32 v28, 3, v28
    v_and_b32 v2, 1, v0
    v_lshl_add_u32 v3, v2, 2, v28
    v_lshlrev_b32 v29, 2, v0
    v_lshlrev_b32 v30, 3, v0
    v_mov_b32 v1, 0
    v_and_b32 v2, 7, v0
    v_lshl_add_u32 v28, v2, 5, v28
    s_lshl_b32 s54, s6, 8
    v_add_u32 v28, s54, v28
    s_mov_b32 s60, 0x00ff00ff
    s_mov_b32 s61, 0x00ff00ff
    s_cmp_lg_u32 s6, 7
    s_cbranch_scc1 L_z_16
    v_mov_b32 v8, 0
    v_mov_b32 v9, 0
    ds_write_b64 v30, v[8:9] offset:18432
L_z_16:
    s_waitcnt lgkmcnt(0)
    s_mul_i32 s7, s42, 0x9e3779b5
    s_add_u32 s7, s7, 0x7f4a7c15
    s_barrier
    s_cmp_lt_u32 s5, 30
    s_cbranch_scc1 L_a_done
    s_cmp_lt_u32 s4, 7
    s_cbranch_scc1 L_a_done
    v_mov_b32 v2, 1
    ds_write_b32 v1, v2 offset:18880
L_a_done:
    s_cmp_lt_u32 s5, 27
    s_cbranch_scc1 L_gu_post
L_mod:
    s_sub_u32 s66, 31, s5
    s_lshl_b32 s66, s66, 3
    s_add_u32 s66, s66, s4
    s_sub_u32 s66, s66, 4
    s_cmp_ge_u32 s66, 36
    s_cbranch_scc1 L_ln
L_mod_go:
    v_lshrrev_b32 v26, 3, v0
    v_mul_u32_u24 v26, 6912, v26
    v_and_b32 v2, 7, v0
    v_lshl_add_u32 v26, v2, 4, v26
    s_mul_i32 s52, s6, 442368
    s_lshl_b32 s67, s66, 7
    s_add_u32 s67, s67, 2304
    s_add_u32 s52, s52, s67
    s_add_u32 s67, s67, 3538944
    s_lshl_b32 s54, s6, 7
    v_lshlrev_b32 v2, 1, v0
    buffer_load_ushort v22, v2, s[48:51], s54 offen
    buffer_load_ushort v23, v2, s[48:51], 0 offen offset:1024
    s_mul_i32 s54, s6, 55296
    s_add_u32 s67, s67, s54
    s_lshl_b32 s54, s6, 5
    v_add_u32 v21, s54, v3
    s_waitcnt vmcnt(0)
    v_lshlrev_b32 v22, 16, v22
    v_lshlrev_b32 v23, 16, v23
    v_max_f32 v22, 0xc3000000, v22
    v_mul_f32 v2, 0xbfb8aa3b, v22
    v_exp_f32 v2, v2
    s_nop 0
    v_add_f32 v2, 1.0, v2
    v_min_f32 v2, 0x7e800000, v2
    v_rcp_f32 v8, v2
    s_nop 0
    v_mul_f32 v9, v22, v8
    v_fma_f32 v22, -v9, v2, v22
    v_fma_f32 v22, v22, v8, v9
    v_cvt_pk_bf16_f32 v22, v22, v22
    v_max_f32 v23, 0xc3000000, v23
    v_mul_f32 v2, 0xbfb8aa3b, v23
    v_exp_f32 v2, v2
    s_nop 0
    v_add_f32 v2, 1.0, v2
    v_min_f32 v2, 0x7e800000, v2
    v_rcp_f32 v8, v2
    s_nop 0
    v_mul_f32 v9, v23, v8
    v_fma_f32 v23, -v9, v2, v23
    v_fma_f32 v23, v23, v8, v9
    v_cvt_pk_bf16_f32 v23, v23, v23
    ds_bpermute_b32 v8, v3, v22 offset:0
    ds_bpermute_b32 v9, v3, v22 offset:32
    ds_bpermute_b32 v10, v3, v22 offset:64
    ds_bpermute_b32 v11, v3, v22 offset:96
    ds_bpermute_b32 v12, v3, v22 offset:128
    ds_bpermute_b32 v13, v3, v22 offset:160
    ds_bpermute_b32 v14, v3, v22 offset:192
    ds_bpermute_b32 v15, v3, v22 offset:224
    s_waitcnt lgkmcnt(7)
    v_and_b32 v96, v8, v4
    v_and_b32 v97, v8, v5
    v_and_b32 v98, v8, v6
    v_and_b32 v99, v8, v7
    s_waitcnt lgkmcnt(6)
    v_and_b32 v100, v9, v4
    v_and_b32 v101, v9, v5
    v_and_b32 v102, v9, v6
    v_and_b32 v103, v9, v7
    s_waitcnt lgkmcnt(5)
    v_and_b32 v104, v10, v4
    v_and_b32 v105, v10, v5
    v_and_b32 v106, v10, v6
    v_and_b32 v107, v10, v7
    s_waitcnt lgkmcnt(4)
    v_and_b32 v108, v11, v4
    v_and_b32 v109, v11, v5
    v_and_b32 v110, v11, v6
    v_and_b32 v111, v11, v7
    s_waitcnt lgkmcnt(3)
    v_and_b32 v112, v12, v4
    v_and_b32 v113, v12, v5
    v_and_b32 v114, v12, v6
    v_and_b32 v115, v12, v7
    s_waitcnt lgkmcnt(2)
    v_and_b32 v116, v13, v4
    v_and_b32 v117, v13, v5
    v_and_b32 v118, v13, v6
    v_and_b32 v119, v13, v7
    s_waitcnt lgkmcnt(1)
    v_and_b32 v120, v14, v4
    v_and_b32 v121, v14, v5
    v_and_b32 v122, v14, v6
    v_and_b32 v123, v14, v7
    s_waitcnt lgkmcnt(0)
    v_and_b32 v124, v15, v4
    v_and_b32 v125, v15, v5
    v_and_b32 v126, v15, v6
    v_and_b32 v127, v15, v7
    ds_bpermute_b32 v8, v21, v23
    s_waitcnt lgkmcnt(0)
    v_and_b32 v36, v8, v4
    v_and_b32 v37, v8, v5
    v_and_b32 v38, v8, v6
    v_and_b32 v39, v8, v7
    buffer_load_dwordx4 v[64:67], v26, s[8:11], s52 offen nt
    s_add_u32 s52, s52, 55296
    s_waitcnt vmcnt(0)
    buffer_load_dwordx4 v[68:71], v26, s[8:11], s52 offen nt
    s_add_u32 s52, s52, 55296
    s_waitcnt vmcnt(0)
    buffer_load_dwordx4 v[72:75], v26, s[8:11], s52 offen nt
    s_add_u32 s52, s52, 55296
    s_waitcnt vmcnt(0)
    buffer_load_dwordx4 v[76:79], v26, s[8:11], s52 offen nt
    s_add_u32 s52, s52, 55296
    s_waitcnt vmcnt(0)
    buffer_load_dwordx4 v[80:83], v26, s[8:11], s52 offen nt
    s_add_u32 s52, s52, 55296
    s_waitcnt vmcnt(0)
    buffer_load_dwordx4 v[84:87], v26, s[8:11], s52 offen nt
    s_add_u32 s52, s52, 55296
    s_mov_b32 s53, 1048576
L_lw_17:
    ds_read_b32 v2, v1 offset:18720
    s_waitcnt lgkmcnt(0)
    v_readfirstlane_b32 s54, v2
    s_cmp_ge_u32 s54, 4
    s_cbranch_scc1 L_lwd_18
    s_sleep 1
    s_sub_u32 s53, s53, 1
    s_cmp_lg_u32 s53, 0
    s_cbranch_scc1 L_lw_17
L_lwd_18:
    buffer_load_dwordx4 v[88:91], v26, s[8:11], s52 offen nt
    s_add_u32 s52, s52, 55296
    buffer_load_dwordx4 v[92:95], v26, s[8:11], s52 offen nt
L_mod_l:
    buffer_load_dwordx4 v[32:35], v26, s[8:11], s67 offen nt
    s_waitcnt vmcnt(8)
    v_mfma_f32_16x16x32_bf16 v[24:27], v[96:99], v[64:67], 0
    s_waitcnt vmcnt(7)
    v_mfma_f32_16x16x32_bf16 v[24:27], v[100:103], v[68:71], v[24:27]
    s_waitcnt vmcnt(6)
    v_mfma_f32_16x16x32_bf16 v[24:27], v[104:107], v[72:75], v[24:27]
    s_waitcnt vmcnt(5)
    v_mfma_f32_16x16x32_bf16 v[24:27], v[108:111], v[76:79], v[24:27]
    s_waitcnt vmcnt(4)
    v_mfma_f32_16x16x32_bf16 v[24:27], v[112:115], v[80:83], v[24:27]
    s_waitcnt vmcnt(3)
    v_mfma_f32_16x16x32_bf16 v[24:27], v[116:119], v[84:87], v[24:27]
    s_waitcnt vmcnt(2)
    v_mfma_f32_16x16x32_bf16 v[24:27], v[120:123], v[88:91], v[24:27]
    s_waitcnt vmcnt(1)
    v_mfma_f32_16x16x32_bf16 v[24:27], v[124:127], v[92:95], v[24:27]
    s_waitcnt vmcnt(0)
    v_mfma_f32_16x16x32_bf16 v[24:27], v[36:39], v[32:35], v[24:27]
    v_mov_b32 v2, 1
    s_nop 6
    v_add_f32_dpp v24, v25, v24 row_ror:8 row_mask:0xf bank_mask:0xf
    v_add_f32_dpp v25, v27, v26 row_ror:8 row_mask:0xf bank_mask:0xf
    s_mov_b64 exec, s[60:61]
    ds_write_b64 v28, v[24:25] offset:13312
    s_mov_b64 exec, 1
    ds_add_rtn_u32 v2, v1, v2 offset:18732
    s_mov_b64 exec, -1
    ds_read2st64_b32 v[104:105], v29 offset0:52 offset1:53
    ds_read2st64_b32 v[106:107], v29 offset0:54 offset1:55
    ds_read2st64_b32 v[108:109], v29 offset0:56 offset1:57
    ds_read2st64_b32 v[110:111], v29 offset0:58 offset1:59
    s_waitcnt lgkmcnt(4)
    v_readfirstlane_b32 s54, v2
    s_cmp_lg_u32 s54, 7
    s_cbranch_scc1 L_mod_end
    s_waitcnt lgkmcnt(3)
    v_add_f32 v8, v104, v105
    s_waitcnt lgkmcnt(2)
    v_add_f32 v106, v106, v107
    v_add_f32 v8, v8, v106
    s_waitcnt lgkmcnt(1)
    v_add_f32 v108, v108, v109
    v_add_f32 v8, v8, v108
    s_waitcnt lgkmcnt(0)
    v_add_f32 v110, v110, v111
    v_add_f32 v8, v8, v110
    v_cvt_pk_bf16_f32 v8, 0, v8
    s_cmp_ge_u32 s66, 27
    s_cbranch_scc1 L_final
    s_lshl_b32 s52, s66, 9
    s_add_u32 s52, s52, 32768
    v_mov_b32 v9, s7
    buffer_store_dwordx2 v[8:9], v30, s[44:47], s52 offen sc1
L_mod_end:
    s_cmp_eq_u32 s5, 31
    s_cbranch_scc1 L_ln
    s_branch L_exit
L_final:
    s_mov_b32 s62, 0x07060501
    s_mov_b32 s63, 0x07060502
    s_mov_b32 s64, 0x07060503
    s_mov_b32 s65, 0x0c04000c
    s_mov_b32 s48, s16
    s_and_b32 s49, s17, 0xffff
    s_mov_b32 s50, 1152
    s_mov_b32 s51, 0x20000
    s_sub_u32 s66, s66, 27
    v_mov_b32 v24, v8
    s_lshl_b32 s54, s66, 7
    v_lshlrev_b32 v23, 1, v0
    v_add_u32 v23, s54, v23
    buffer_load_ushort v25, v23, s[48:51], 0 offen
    s_lshl_b32 s67, s66, 9
    s_add_u32 s67, s67, 32768
    s_lshl_b32 s68, s66, 12
    s_add_u32 s69, s68, 1245184
    s_lshr_b32 s68, s68, 0
    s_add_u32 s68, s68, 1179648
    v_lshlrev_b32 v27, 4, v0
    s_mov_b32 s53, 1048576
L_lw_19:
    ds_read_b32 v2, v1 offset:18736
    s_waitcnt lgkmcnt(0)
    v_readfirstlane_b32 s54, v2
    s_cmp_ge_u32 s54, 1
    s_cbranch_scc1 L_lwd_20
    s_sleep 1
    s_sub_u32 s53, s53, 1
    s_cmp_lg_u32 s53, 0
    s_cbranch_scc1 L_lw_19
L_lwd_20:
    s_mov_b32 s53, 0
    buffer_load_dwordx2 v[20:21], v30, s[44:47], s67 offen sc1
    s_branch L_gc_23
L_g_21:
    s_mov_b64 exec, vcc
    buffer_load_dwordx2 v[20:21], v30, s[44:47], s67 offen sc1
    s_mov_b64 exec, -1
L_gc_23:
    s_waitcnt vmcnt(0)
    v_cmp_ne_u32_e64 s[70:71], s7, v21
    s_or_b64 vcc, s[70:71], s[70:71]
    s_cbranch_scc0 L_gd_22
    s_add_u32 s53, s53, 1
    s_cmp_lt_u32 s53, 131072
    s_cbranch_scc1 L_g_21
L_gd_22:
    s_mov_b32 s53, 0
    buffer_load_dwordx4 v[32:35], v27, s[44:47], s68 offen offset:0 sc1
    buffer_load_dwordx4 v[36:39], v27, s[44:47], s68 offen offset:1024 sc1
    buffer_load_dwordx4 v[40:43], v27, s[44:47], s68 offen offset:2048 sc1
    buffer_load_dwordx4 v[44:47], v27, s[44:47], s68 offen offset:3072 sc1
    s_branch L_gc_26
L_g_24:
    s_mov_b64 exec, s[70:71]
    s_cbranch_execz L_gs_27
    buffer_load_dwordx4 v[32:35], v27, s[44:47], s68 offen offset:0 sc1
L_gs_27:
    s_mov_b64 exec, s[72:73]
    s_cbranch_execz L_gs_28
    buffer_load_dwordx4 v[36:39], v27, s[44:47], s68 offen offset:1024 sc1
L_gs_28:
    s_mov_b64 exec, s[74:75]
    s_cbranch_execz L_gs_29
    buffer_load_dwordx4 v[40:43], v27, s[44:47], s68 offen offset:2048 sc1
L_gs_29:
    s_mov_b64 exec, s[76:77]
    s_cbranch_execz L_gs_30
    buffer_load_dwordx4 v[44:47], v27, s[44:47], s68 offen offset:3072 sc1
L_gs_30:
    s_mov_b64 exec, -1
L_gc_26:
    s_waitcnt vmcnt(0)
    v_cmp_ne_u32_e64 s[70:71], s7, v35
    v_cmp_ne_u32_e64 s[72:73], s7, v39
    v_cmp_ne_u32_e64 s[74:75], s7, v43
    v_cmp_ne_u32_e64 s[76:77], s7, v47
    s_or_b64 vcc, s[70:71], s[72:73]
    s_or_b64 vcc, vcc, s[74:75]
    s_or_b64 vcc, vcc, s[76:77]
    s_cbranch_scc0 L_gd_25
    s_add_u32 s53, s53, 1
    s_cmp_lt_u32 s53, 131072
    s_cbranch_scc1 L_g_24
L_gd_25:
    v_add_f32 v32, v32, v36
    v_add_f32 v33, v33, v37
    v_add_f32 v40, v40, v44
    v_add_f32 v41, v41, v45
    v_add_f32 v32, v32, v40
    v_add_f32 v33, v33, v41
    s_nop 1
    v_permlane32_swap_b32 v32, v33
    v_add_f32 v8, v32, v33
    v_lshlrev_b32 v25, 16, v25
    v_cvt_pk_bf16_f32 v8, 0, v8
    v_mul_f32 v8, v20, v8
    v_cvt_pk_bf16_f32 v8, 0, v8
    v_add_f32 v8, v25, v8
    v_cvt_pk_bf16_f32 v8, 0, v8
    v_mov_b32 v25, v8
    s_cmp_lg_u32 s66, 0
    s_cbranch_scc1 L_noep
    v_mov_b32 v9, s7
    s_mov_b64 exec, 1
    buffer_store_dword v9, v1, s[44:47], 0 offen sc1
    s_mov_b64 exec, -1
L_noep:
    s_mov_b32 s48, s38
    s_and_b32 s49, s39, 0xffff
    s_mov_b32 s50, 1152
    s_mov_b32 s51, 0x20000
    s_mov_b32 s53, 0
    buffer_load_dwordx4 v[32:35], v27, s[44:47], s69 offen offset:0 sc1
    buffer_load_dwordx4 v[36:39], v27, s[44:47], s69 offen offset:1024 sc1
    buffer_load_dwordx4 v[40:43], v27, s[44:47], s69 offen offset:2048 sc1
    buffer_load_dwordx4 v[44:47], v27, s[44:47], s69 offen offset:3072 sc1
    s_sleep 2
L_pg_31:
    buffer_load_dwordx4 v[48:51], v27, s[44:47], s69 offen offset:0 sc1
    buffer_load_dwordx4 v[52:55], v27, s[44:47], s69 offen offset:1024 sc1
    buffer_load_dwordx4 v[56:59], v27, s[44:47], s69 offen offset:2048 sc1
    buffer_load_dwordx4 v[60:63], v27, s[44:47], s69 offen offset:3072 sc1
    s_waitcnt vmcnt(4)
    v_cmp_ne_u32 vcc, s7, v35
    v_cmp_ne_u32_e64 s[56:57], s7, v39
    s_or_b64 vcc, vcc, s[56:57]
    v_cmp_ne_u32_e64 s[58:59], s7, v43
    s_or_b64 vcc, vcc, s[58:59]
    v_cmp_ne_u32_e64 s[56:57], s7, v47
    s_or_b64 vcc, vcc, s[56:57]
    s_cbranch_scc0 L_pgo_33
    buffer_load_dwordx4 v[32:35], v27, s[44:47], s69 offen offset:0 sc1
    buffer_load_dwordx4 v[36:39], v27, s[44:47], s69 offen offset:1024 sc1
    buffer_load_dwordx4 v[40:43], v27, s[44:47], s69 offen offset:2048 sc1
    buffer_load_dwordx4 v[44:47], v27, s[44:47], s69 offen offset:3072 sc1
    s_waitcnt vmcnt(4)
    v_cmp_ne_u32 vcc, s7, v51
    v_cmp_ne_u32_e64 s[56:57], s7, v55
    s_or_b64 vcc, vcc, s[56:57]
    v_cmp_ne_u32_e64 s[58:59], s7, v59
    s_or_b64 vcc, vcc, s[58:59]
    v_cmp_ne_u32_e64 s[56:57], s7, v63
    s_or_b64 vcc, vcc, s[56:57]
    s_cbranch_scc0 L_pgo_34
    s_add_u32 s53, s53, 1
    s_cmp_lt_u32 s53, 131072
    s_cbranch_scc1 L_pg_31
L_pgo_33:
    v_add_f32 v12, v32, v36
    v_add_f32 v13, v33, v37
    v_add_f32 v14, v40, v44
    v_add_f32 v15, v41, v45
    s_branch L_pgd_32
L_pgo_34:
    v_add_f32 v12, v48, v52
    v_add_f32 v13, v49, v53
    v_add_f32 v14, v56, v60
    v_add_f32 v15, v57, v61
L_pgd_32:
    v_add_f32 v12, v12, v14
    v_add_f32 v13, v13, v15
    s_nop 1
    v_permlane32_swap_b32 v12, v13
    v_add_f32 v8, v12, v13
    v_cvt_pk_bf16_f32 v8, 0, v8
    v_mul_f32 v8, v24, v8
    v_cvt_pk_bf16_f32 v8, 0, v8
    v_add_f32 v8, v25, v8
    v_cvt_pk_bf16_f32 v8, v8, v8
    buffer_store_short v8, v23, s[48:51], 0 offen
    s_branch L_exit
L_q:
    s_sub_u32 s66, s5, 9
    s_and_b32 s67, s66, 1
    s_lshr_b32 s68, s66, 1
    s_mul_i32 s69, s67, 5
    s_add_u32 s69, s69, s6
    s_sub_u32 s89, 5, s67
    s_mov_b32 s8, s22
    s_and_b32 s9, s23, 0xffff
    s_mov_b32 s10, 4718592
    s_mov_b32 s11, 0x20000
    s_mov_b32 s48, s16
    s_and_b32 s49, s17, 0xffff
    s_mov_b32 s50, 1152
    s_mov_b32 s51, 0x20000
    v_lshrrev_b32 v26, 3, v0
    v_mul_u32_u24 v26, 8192, v26
    v_and_b32 v2, 7, v0
    v_lshl_add_u32 v26, v2, 4, v26
    s_cmp_ge_u32 s6, s89
    s_cbranch_scc1 L_a_skip
    s_lshl_b32 s52, s69, 19
    s_lshl_b32 s54, s4, 10
    s_add_u32 s52, s52, s54
    s_lshl_b32 s54, s68, 7
    s_add_u32 s52, s52, s54
    s_lshl_b32 s54, s69, 7
    v_lshlrev_b32 v2, 1, v0
    buffer_load_ushort v25, v2, s[48:51], s54 offen
    buffer_load_ushort v9, v2, s[48:51], 0 offen offset:0
    buffer_load_ushort v10, v2, s[48:51], 0 offen offset:128
    buffer_load_ushort v11, v2, s[48:51], 0 offen offset:256
    buffer_load_ushort v12, v2, s[48:51], 0 offen offset:384
    buffer_load_ushort v13, v2, s[48:51], 0 offen offset:512
    buffer_load_ushort v14, v2, s[48:51], 0 offen offset:640
    buffer_load_ushort v15, v2, s[48:51], 0 offen offset:768
    buffer_load_ushort v16, v2, s[48:51], 0 offen offset:896
    buffer_load_ushort v17, v2, s[48:51], 0 offen offset:1024
    buffer_load_dwordx4 v[32:35], v26, s[8:11], s52 offen nt
    s_add_u32 s52, s52, 65536
    buffer_load_dwordx4 v[36:39], v26, s[8:11], s52 offen nt
    s_add_u32 s52, s52, 65536
    v_bfe_u32 v2, v0, 1, 1
    v_cmp_eq_u32 vcc, 1, v2
    v_mov_b32 v3, 0xffff
    v_mov_b32 v8, 0xffff0000
    v_cndmask_b32 v3, v3, v8, vcc
    v_bfe_u32 v2, v0, 2, 2
    v_cmp_eq_u32 vcc, 0, v2
    s_nop 1
    v_cndmask_b32 v4, 0, v3, vcc
    v_cmp_eq_u32 vcc, 1, v2
    s_nop 1
    v_cndmask_b32 v5, 0, v3, vcc
    v_cmp_eq_u32 vcc, 2, v2
    s_nop 1
    v_cndmask_b32 v6, 0, v3, vcc
    v_cmp_eq_u32 vcc, 3, v2
    s_nop 1
    v_cndmask_b32 v7, 0, v3, vcc
    v_lshrrev_b32 v28, 4, v0
    v_lshlrev_b32 v28, 3, v28
    v_and_b32 v2, 1, v0
    v_lshl_add_u32 v3, v2, 2, v28
    v_lshlrev_b32 v29, 2, v0
    v_lshlrev_b32 v30, 3, v0
    v_mov_b32 v1, 0
    v_and_b32 v2, 7, v0
    v_lshl_add_u32 v28, v2, 5, v28
    s_lshl_b32 s54, s6, 8
    v_add_u32 v28, s54, v28
    s_mov_b32 s60, 0x00ff00ff
    s_mov_b32 s61, 0x00ff00ff
    s_waitcnt lgkmcnt(0)
    s_mul_i32 s7, s42, 0x9e3779b5
    s_add_u32 s7, s7, 0x7f4a7c15
    s_barrier
    s_waitcnt vmcnt(1)
    buffer_load_dwordx4 v[40:43], v26, s[8:11], s52 offen nt
    s_add_u32 s52, s52, 65536
    s_waitcnt vmcnt(1)
    buffer_load_dwordx4 v[44:47], v26, s[8:11], s52 offen nt
    s_add_u32 s52, s52, 65536
    s_waitcnt vmcnt(1)
    buffer_load_dwordx4 v[48:51], v26, s[8:11], s52 offen nt
    s_add_u32 s52, s52, 65536
    s_waitcnt vmcnt(1)
    buffer_load_dwordx4 v[52:55], v26, s[8:11], s52 offen nt
    s_add_u32 s52, s52, 65536
    s_waitcnt vmcnt(1)
    buffer_load_dwordx4 v[56:59], v26, s[8:11], s52 offen nt
    s_add_u32 s52, s52, 65536
    s_waitcnt vmcnt(1)
    buffer_load_dwordx4 v[60:63], v26, s[8:11], s52 offen nt
    s_waitcnt vmcnt(8)
    v_lshlrev_b32 v25, 16, v25
    v_lshlrev_b32 v9, 16, v9
    v_lshlrev_b32 v10, 16, v10
    v_lshlrev_b32 v11, 16, v11
    v_lshlrev_b32 v12, 16, v12
    v_lshlrev_b32 v13, 16, v13
    v_lshlrev_b32 v14, 16, v14
    v_lshlrev_b32 v15, 16, v15
    v_lshlrev_b32 v16, 16, v16
    v_lshlrev_b32 v17, 16, v17
    v_add_f32 v18, v9, v10
    v_add_f32 v18, v18, v11
    v_add_f32 v18, v18, v12
    v_add_f32 v18, v18, v13
    v_add_f32 v18, v18, v14
    v_add_f32 v18, v18, v15
    v_add_f32 v18, v18, v16
    v_add_f32 v18, v18, v17
    s_nop 1
    v_add_f32_dpp v18, v18, v18 row_ror:8 row_mask:0xf bank_mask:0xf
    s_nop 1
    v_add_f32_dpp v18, v18, v18 row_ror:4 row_mask:0xf bank_mask:0xf
    s_nop 1
    v_add_f32_dpp v18, v18, v18 row_ror:2 row_mask:0xf bank_mask:0xf
    s_nop 1
    v_add_f32_dpp v18, v18, v18 row_ror:1 row_mask:0xf bank_mask:0xf
    s_nop 1
    v_add_f32_dpp v18, v18, v18 row_bcast:15 row_mask:0xa bank_mask:0xf
    s_nop 1
    v_add_f32_dpp v18, v18, v18 row_bcast:31 row_mask:0xc bank_mask:0xf
    v_mul_f32 v18, 0x3ae38e39, v18
    s_nop 0
    v_readlane_b32 s90, v18, 63
    v_mov_b32 v19, 0
    s_nop 0
    v_subrev_f32 v9, s90, v9
    v_fmac_f32 v19, v9, v9
    v_subrev_f32 v10, s90, v10
    v_fmac_f32 v19, v10, v10
    v_subrev_f32 v11, s90, v11
    v_fmac_f32 v19, v11, v11
    v_subrev_f32 v12, s90, v12
    v_fmac_f32 v19, v12, v12
    v_subrev_f32 v13, s90, v13
    v_fmac_f32 v19, v13, v13
    v_subrev_f32 v14, s90, v14
    v_fmac_f32 v19, v14, v14
    v_subrev_f32 v15, s90, v15
    v_fmac_f32 v19, v15, v15
    v_subrev_f32 v16, s90, v16
    v_fmac_f32 v19, v16, v16
    v_subrev_f32 v17, s90, v17
    v_fmac_f32 v19, v17, v17
    s_nop 1
    v_add_f32_dpp v19, v19, v19 row_ror:8 row_mask:0xf bank_mask:0xf
    s_nop 1
    v_add_f32_dpp v19, v19, v19 row_ror:4 row_mask:0xf bank_mask:0xf
    s_nop 1
    v_add_f32_dpp v19, v19, v19 row_ror:2 row_mask:0xf bank_mask:0xf
    s_nop 1
    v_add_f32_dpp v19, v19, v19 row_ror:1 row_mask:0xf bank_mask:0xf
    s_nop 1
    v_add_f32_dpp v19, v19, v19 row_bcast:15 row_mask:0xa bank_mask:0xf
    s_nop 1
    v_add_f32_dpp v19, v19, v19 row_bcast:31 row_mask:0xc bank_mask:0xf
    v_mul_f32 v19, 0x3ae38e39, v19
    s_nop 0
    v_readlane_b32 s91, v19, 63
    v_mov_b32 v18, s90
    s_nop 0
    v_mov_b32 v19, s91
    v_cvt_pk_bf16_f32 v19, 0, v19
    v_cvt_pk_bf16_f32 v18, 0, v18
    v_add_f32 v19, 0x3727c5ac, v19
    v_sub_f32 v24, v25, v18
    v_cvt_pk_bf16_f32 v19, 0, v19
    v_sqrt_f32 v19, v19
    v_cvt_pk_bf16_f32 v24, 0, v24
    v_cvt_pk_bf16_f32 v19, 0, v19
    v_rcp_f32 v19, v19
    s_nop 0
    v_mul_f32 v24, v24, v19
    v_cvt_pk_bf16_f32 v24, 0, v24
    s_lshl_b32 s90, s69, 9
    s_add_u32 s90, s90, 4096
    s_add_u32 s91, s90, 4608
    s_add_u32 s92, s90, 9216
    s_add_u32 s93, s91, 9216
    s_add_u32 s94, s92, 9216
    s_add_u32 s95, s93, 9216
    s_lshl_b32 s52, s4, 13
    s_lshr_b32 s54, s68, 2
    s_lshl_b32 s54, s54, 12
    s_add_u32 s52, s52, s54
    s_lshl_b32 s54, s67, 11
    s_add_u32 s52, s52, s54
    s_and_b32 s54, s68, 3
    s_lshl_b32 s54, s54, 9
    s_add_u32 s52, s52, s54
    s_add_u32 s52, s52, 131072
    s_cmp_lg_u32 s6, 0
    s_cbranch_scc1 L_pw_35
    buffer_load_dwordx2 v[20:21], v30, s[44:47], s52 offen nt
    s_xor_b32 s54, s7, 1
    v_mov_b32 v97, s54
    buffer_store_dwordx2 v[96:97], v30, s[44:47], s52 offen
L_pw_35:
    s_mov_b32 s53, 0
    buffer_load_dwordx2 v[8:9], v30, s[44:47], s90 offen sc1
    buffer_load_dwordx2 v[10:11], v30, s[44:47], s91 offen sc1
    buffer_load_dwordx2 v[12:13], v30, s[44:47], s92 offen sc1
    buffer_load_dwordx2 v[14:15], v30, s[44:47], s93 offen sc1
    buffer_load_dwordx2 v[16:17], v30, s[44:47], s94 offen sc1
    buffer_load_dwordx2 v[18:19], v30, s[44:47], s95 offen sc1
    s_branch L_gc_38
L_g_36:
    s_mov_b64 exec, s[70:71]
    s_cbranch_execz L_gs_39
    buffer_load_dwordx2 v[8:9], v30, s[44:47], s90 offen sc1
L_gs_39:
    s_mov_b64 exec, s[72:73]
    s_cbranch_execz L_gs_40
    buffer_load_dwordx2 v[10:11], v30, s[44:47], s91 offen sc1
L_gs_40:
    s_mov_b64 exec, s[74:75]
    s_cbranch_execz L_gs_41
    buffer_load_dwordx2 v[12:13], v30, s[44:47], s92 offen sc1
L_gs_41:
    s_mov_b64 exec, s[76:77]
    s_cbranch_execz L_gs_42
    buffer_load_dwordx2 v[14:15], v30, s[44:47], s93 offen sc1
L_gs_42:
    s_mov_b64 exec, s[78:79]
    s_cbranch_execz L_gs_43
    buffer_load_dwordx2 v[16:17], v30, s[44:47], s94 offen sc1
L_gs_43:
    s_mov_b64 exec, s[58:59]
    s_cbranch_execz L_gs_44
    buffer_load_dwordx2 v[18:19], v30, s[44:47], s95 offen sc1
L_gs_44:
    s_mov_b64 exec, -1
L_gc_38:
    s_waitcnt vmcnt(0)
    v_cmp_ne_u32_e64 s[70:71], s7, v9
    v_cmp_ne_u32_e64 s[72:73], s7, v11
    v_cmp_ne_u32_e64 s[74:75], s7, v13
    v_cmp_ne_u32_e64 s[76:77], s7, v15
    v_cmp_ne_u32_e64 s[78:79], s7, v17
    v_cmp_ne_u32_e64 s[58:59], s7, v19
    s_or_b64 vcc, s[70:71], s[72:73]
    s_or_b64 vcc, vcc, s[74:75]
    s_or_b64 vcc, vcc, s[76:77]
    s_or_b64 vcc, vcc, s[78:79]
    s_or_b64 vcc, vcc, s[58:59]
    s_cbranch_scc0 L_gd_37
    s_add_u32 s53, s53, 1
    s_cmp_lt_u32 s53, 131072
    s_cbranch_scc1 L_g_36
L_gd_37:
    v_add_f32 v8, v8, v12
    v_add_f32 v10, v10, v14
    v_add_f32 v8, v8, v16
    v_add_f32 v10, v10, v18
    v_cvt_pk_bf16_f32 v10, 0, v10
    v_cvt_pk_bf16_f32 v8, 0, v8
    v_add_f32 v10, 1.0, v10
    v_cvt_pk_bf16_f32 v10, 0, v10
    v_mul_f32 v10, v24, v10
    v_cvt_pk_bf16_f32 v10, 0, v10
    v_add_f32 v10, v10, v8
    v_cvt_pk_bf16_f32 v23, v10, v10
    ds_bpermute_b32 v8, v3, v23 offset:0
    ds_bpermute_b32 v9, v3, v23 offset:32
    ds_bpermute_b32 v10, v3, v23 offset:64
    ds_bpermute_b32 v11, v3, v23 offset:96
    ds_bpermute_b32 v12, v3, v23 offset:128
    ds_bpermute_b32 v13, v3, v23 offset:160
    ds_bpermute_b32 v14, v3, v23 offset:192
    ds_bpermute_b32 v15, v3, v23 offset:224
    s_waitcnt lgkmcnt(7)
    v_and_b32 v96, v8, v4
    v_and_b32 v97, v8, v5
    v_and_b32 v98, v8, v6
    v_and_b32 v99, v8, v7
    s_waitcnt lgkmcnt(6)
    v_and_b32 v100, v9, v4
    v_and_b32 v101, v9, v5
    v_and_b32 v102, v9, v6
    v_and_b32 v103, v9, v7
    v_mfma_f32_16x16x32_bf16 v[24:27], v[96:99], v[32:35], 0
    s_waitcnt lgkmcnt(5)
    v_and_b32 v104, v10, v4
    v_and_b32 v105, v10, v5
    v_and_b32 v106, v10, v6
    v_and_b32 v107, v10, v7
    v_mfma_f32_16x16x32_bf16 v[24:27], v[100:103], v[36:39], v[24:27]
    s_waitcnt lgkmcnt(4)
    v_and_b32 v108, v11, v4
    v_and_b32 v109, v11, v5
    v_and_b32 v110, v11, v6
    v_and_b32 v111, v11, v7
    v_mfma_f32_16x16x32_bf16 v[24:27], v[104:107], v[40:43], v[24:27]
    s_waitcnt lgkmcnt(3)
    v_and_b32 v112, v12, v4
    v_and_b32 v113, v12, v5
    v_and_b32 v114, v12, v6
    v_and_b32 v115, v12, v7
    v_mfma_f32_16x16x32_bf16 v[24:27], v[108:111], v[44:47], v[24:27]
    s_waitcnt lgkmcnt(2)
    v_and_b32 v116, v13, v4
    v_and_b32 v117, v13, v5
    v_and_b32 v118, v13, v6
    v_and_b32 v119, v13, v7
    v_mfma_f32_16x16x32_bf16 v[24:27], v[112:115], v[48:51], v[24:27]
    s_waitcnt lgkmcnt(1)
    v_and_b32 v120, v14, v4
    v_and_b32 v121, v14, v5
    v_and_b32 v122, v14, v6
    v_and_b32 v123, v14, v7
    v_mfma_f32_16x16x32_bf16 v[24:27], v[116:119], v[52:55], v[24:27]
    s_waitcnt lgkmcnt(0)
    v_and_b32 v124, v15, v4
    v_and_b32 v125, v15, v5
    v_and_b32 v126, v15, v6
    v_and_b32 v127, v15, v7
    v_mfma_f32_16x16x32_bf16 v[24:27], v[120:123], v[56:59], v[24:27]
    s_nop 0
    v_mfma_f32_16x16x32_bf16 v[24:27], v[124:127], v[60:63], v[24:27]
    v_mov_b32 v2, 1
    s_nop 6
    v_add_f32_dpp v24, v25, v24 row_ror:8 row_mask:0xf bank_mask:0xf
    v_add_f32_dpp v25, v27, v26 row_ror:8 row_mask:0xf bank_mask:0xf
    s_mov_b64 exec, s[60:61]
    ds_write_b64 v28, v[24:25] offset:8192
    s_mov_b64 exec, 1
    ds_add_rtn_u32 v2, v1, v2 offset:18728
    s_mov_b64 exec, -1
    ds_read2st64_b32 v[104:105], v29 offset0:32 offset1:33
    ds_read2st64_b32 v[106:107], v29 offset0:34 offset1:35
    ds_read_b32 v108, v29 offset:9216
    s_waitcnt lgkmcnt(3)
    v_readfirstlane_b32 s54, v2
    s_add_u32 s54, s54, 1
    s_cmp_lg_u32 s54, s89
    s_cbranch_scc1 L_gu_post
    s_cmp_eq_u32 s89, 5
    s_cselect_b32 s54, -1, 0
    s_waitcnt lgkmcnt(2)
    v_add_f32 v8, v104, v105
    s_waitcnt lgkmcnt(1)
    v_add_f32 v106, v106, v107
    v_add_f32 v8, v8, v106
    s_waitcnt lgkmcnt(0)
    v_and_b32 v108, s54, v108
    v_add_f32 v8, v8, v108
    v_mov_b32 v9, s7
    buffer_store_dwordx2 v[8:9], v30, s[44:47], s52 offen
    s_add_u32 s54, s52, 524288
    buffer_store_dwordx2 v[8:9], v30, s[44:47], s54 offen sc1
    v_mov_b32 v2, 1
    ds_write_b32 v1, v2 offset:18880
L_gu_post:
    s_sub_u32 s66, s5, 9
    s_and_b32 s67, s66, 1
    s_lshr_b32 s68, s66, 1
    s_cmp_eq_u32 s67, 0
    s_cselect_b32 s12, s28, s30
    s_cselect_b32 s13, s29, s31
    s_and_b32 s13, s13, 0xffff
    s_mov_b32 s14, 5308416
    s_mov_b32 s15, 0x20000
    v_lshrrev_b32 v26, 3, v0
    v_mul_u32_u24 v26, 9216, v26
    v_lshrrev_b32 v2, 3, v0
    v_and_b32 v2, 6, v2
    v_xor_b32 v2, v2, v0
    v_and_b32 v2, 7, v2
    v_lshl_add_u32 v26, v2, 4, v26
    s_lshl_b32 s54, s6, 13
    s_add_u32 m0, s54, 86016
    s_mul_i32 s52, s6, 589824
    s_mul_i32 s54, s4, 9
    s_add_u32 s93, s54, s6
    s_add_u32 s54, s54, s68
    s_lshl_b32 s54, s54, 7
    s_add_u32 s52, s52, s54
    s_lshl_b32 s93, s93, 9
    s_add_u32 s93, s93, 303104
    s_lshl_b32 s94, s4, 1
    s_add_u32 s94, s94, s67
    s_mul_i32 s94, s94, 4608
    s_lshl_b32 s54, s68, 9
    s_add_u32 s94, s94, s54
    s_add_u32 s94, s94, 229376
    v_mov_b32 v25, v30
    s_cmp_lg_u32 s6, 7
    s_cbranch_scc1 L_pw_45
    buffer_load_dwordx2 v[20:21], v30, s[44:47], s94 offen nt
    s_xor_b32 s54, s7, 1
    v_mov_b32 v97, s54
    buffer_store_dwordx2 v[96:97], v30, s[44:47], s94 offen
L_pw_45:
    s_mov_b32 s53, 1048576
L_lw_46:
    ds_read_b32 v2, v1 offset:18720
    s_waitcnt lgkmcnt(0)
    v_readfirstlane_b32 s54, v2
    s_cmp_ge_u32 s54, 4
    s_cbranch_scc1 L_lwd_47
    s_sleep 1
    s_sub_u32 s53, s53, 1
    s_cmp_lg_u32 s53, 0
    s_cbranch_scc1 L_lw_46
L_lwd_47:
    buffer_load_dwordx4 v26, s[12:15], s52 offen nt lds
    s_addk_i32 m0, 0x400
    s_add_u32 s52, s52, 73728
    buffer_load_dwordx4 v26, s[12:15], s52 offen nt lds
    s_addk_i32 m0, 0x400
    s_add_u32 s52, s52, 73728
    s_mov_b32 s53, 1048576
L_lw_48:
    ds_read_b32 v2, v1 offset:18736
    s_waitcnt lgkmcnt(0)
    v_readfirstlane_b32 s54, v2
    s_cmp_ge_u32 s54, 1
    s_cbranch_scc1 L_lwd_49
    s_sleep 1
    s_sub_u32 s53, s53, 1
    s_cmp_lg_u32 s53, 0
    s_cbranch_scc1 L_lw_48
L_lwd_49:
    buffer_load_dwordx4 v26, s[12:15], s52 offen nt lds
    s_addk_i32 m0, 0x400
    s_add_u32 s52, s52, 73728
    buffer_load_dwordx4 v26, s[12:15], s52 offen nt lds
    s_addk_i32 m0, 0x400
    s_add_u32 s52, s52, 73728
    buffer_load_dwordx4 v26, s[12:15], s52 offen nt lds
    s_addk_i32 m0, 0x400
    s_add_u32 s52, s52, 73728
    buffer_load_dwordx4 v26, s[12:15], s52 offen nt lds
    s_addk_i32 m0, 0x400
    s_add_u32 s52, s52, 73728
    buffer_load_dwordx4 v26, s[12:15], s52 offen nt lds
    s_addk_i32 m0, 0x400
    s_add_u32 s52, s52, 73728
    buffer_load_dwordx4 v26, s[12:15], s52 offen nt lds
    s_lshl_b32 s54, s6, 13
    s_add_u32 s54, s54, 86016
    v_lshrrev_b32 v8, 4, v0
    v_lshlrev_b32 v8, 10, v8
    v_bfe_u32 v2, v0, 2, 2
    v_lshl_add_u32 v8, v2, 7, v8
    v_and_b32 v2, 3, v0
    v_lshl_add_u32 v8, v2, 3, v8
    v_bfe_u32 v2, v0, 3, 1
    v_lshl_add_u32 v8, v2, 5, v8
    v_add_u32 v8, s54, v8
    v_xor_b32 v9, 32, v8
    v_xor_b32 v10, 64, v8
    v_xor_b32 v11, 0x60, v8
    s_lshl_b32 s54, s6, 7
    v_lshl_add_u32 v98, v0, 1, s54
    v_and_b32 v2, 48, v0
    v_add_u32 v99, s54, v2
    s_lshl_b32 s54, s6, 8
    v_add_u32 v97, s54, v29
    s_mov_b32 s60, 0xffff0000
    s_mov_b32 s61, 0
    s_mov_b32 s84, 0
    s_mov_b32 s85, 0xffff
    s_mov_b32 s86, 0
    s_mov_b32 s87, 0xffff0000
    s_waitcnt vmcnt(0)
    ds_read_b64_tr_b16 v[64:65], v8 offset:0
    ds_read_b64_tr_b16 v[66:67], v10 offset:512
    ds_read_b64_tr_b16 v[68:69], v9 offset:0
    ds_read_b64_tr_b16 v[70:71], v11 offset:512
    ds_read_b64_tr_b16 v[72:73], v10 offset:0
    ds_read_b64_tr_b16 v[74:75], v8 offset:512
    ds_read_b64_tr_b16 v[76:77], v11 offset:0
    ds_read_b64_tr_b16 v[78:79], v9 offset:512
    ds_read_b64_tr_b16 v[80:81], v8 offset:4096
    ds_read_b64_tr_b16 v[82:83], v10 offset:4608
    ds_read_b64_tr_b16 v[84:85], v9 offset:4096
    ds_read_b64_tr_b16 v[86:87], v11 offset:4608
    ds_read_b64_tr_b16 v[88:89], v10 offset:4096
    ds_read_b64_tr_b16 v[90:91], v8 offset:4608
    ds_read_b64_tr_b16 v[92:93], v11 offset:4096
    ds_read_b64_tr_b16 v[94:95], v9 offset:4608
    s_waitcnt lgkmcnt(0)
    s_mov_b32 s53, 0
    buffer_load_dwordx2 v[22:23], v25, s[44:47], s93 offen sc1
    s_branch L_gc_52
L_g_50:
    s_mov_b64 exec, vcc
    buffer_load_dwordx2 v[22:23], v25, s[44:47], s93 offen sc1
    s_mov_b64 exec, -1
L_gc_52:
    s_waitcnt vmcnt(0)
    v_cmp_ne_u32_e64 s[70:71], s7, v23
    s_or_b64 vcc, s[70:71], s[70:71]
    s_cbranch_scc0 L_gd_51
    s_add_u32 s53, s53, 1
    s_cmp_eq_u32 s53, 128
    s_cselect_b32 s54, 524288, 0
    v_add_u32 v25, s54, v25
    s_cmp_lt_u32 s53, 131072
    s_cbranch_scc1 L_g_50
L_gd_51:
    ds_write_b16 v98, v22 offset:11264
    ds_read_b128 v[100:103], v99 offset:11264
    ds_read_b128 v[104:107], v99 offset:11328
    s_waitcnt lgkmcnt(1)
    v_mfma_f32_16x16x32_bf16 v[108:111], v[100:103], v[64:67], 0
    v_mfma_f32_16x16x32_bf16 v[112:115], v[100:103], v[68:71], 0
    v_mfma_f32_16x16x32_bf16 v[116:119], v[100:103], v[72:75], 0
    v_mfma_f32_16x16x32_bf16 v[120:123], v[100:103], v[76:79], 0
    s_waitcnt lgkmcnt(0)
    v_mfma_f32_16x16x32_bf16 v[108:111], v[104:107], v[80:83], v[108:111]
    v_mfma_f32_16x16x32_bf16 v[112:115], v[104:107], v[84:87], v[112:115]
    v_mfma_f32_16x16x32_bf16 v[116:119], v[104:107], v[88:91], v[116:119]
    v_mfma_f32_16x16x32_bf16 v[120:123], v[104:107], v[92:95], v[120:123]
    v_mov_b32 v2, 1
    s_nop 4
    v_cndmask_b32_e64 v108, v108, v112, s[60:61]
    v_cndmask_b32_e64 v108, v108, v116, s[84:85]
    v_cndmask_b32_e64 v108, v108, v120, s[86:87]
    ds_write_b32 v97, v108 offset:13312
    s_mov_b64 exec, 1
    ds_add_rtn_u32 v2, v1, v2 offset:18732
    s_mov_b64 exec, -1
    ds_read2st64_b32 v[12:13], v29 offset0:52 offset1:53
    ds_read2st64_b32 v[14:15], v29 offset0:54 offset1:55
    ds_read2st64_b32 v[16:17], v29 offset0:56 offset1:57
    ds_read2st64_b32 v[18:19], v29 offset0:58 offset1:59
    ds_read_b32 v20, v29 offset:15360
    s_waitcnt lgkmcnt(5)
    v_readfirstlane_b32 s54, v2
    s_cmp_lg_u32 s54, 8
    s_cbranch_scc1 L_exit
    s_waitcnt lgkmcnt(4)
    v_add_f32 v8, v12, v13
    s_waitcnt lgkmcnt(3)
    v_add_f32 v14, v14, v15
    v_add_f32 v8, v8, v14
    s_waitcnt lgkmcnt(2)
    v_add_f32 v16, v16, v17
    v_add_f32 v8, v8, v16
    s_waitcnt lgkmcnt(1)
    v_add_f32 v18, v18, v19
    v_add_f32 v8, v8, v18
    s_waitcnt lgkmcnt(0)
    v_add_f32 v8, v8, v20
    v_cvt_pk_bf16_f32 v8, 0, v8
    v_mov_b32 v9, s7
    buffer_store_dwordx2 v[8:9], v30, s[44:47], s94 offen
    s_add_u32 s54, s94, 524288
    buffer_store_dwordx2 v[8:9], v30, s[44:47], s54 offen sc1
    s_branch L_exit
L_ln:
    s_mov_b32 s48, s16
    s_and_b32 s49, s17, 0xffff
    s_mov_b32 s50, 1152
    s_mov_b32 s51, 0x20000
    s_mov_b32 s62, 0x07060501
    s_mov_b32 s63, 0x07060502
    s_mov_b32 s64, 0x07060503
    s_mov_b32 s65, 0x0c04000c
    s_lshl_b32 s54, s6, 7
    v_lshlrev_b32 v2, 1, v0
    buffer_load_ushort v25, v2, s[48:51], s54 offen
    s_lshl_b32 s90, s6, 9
    s_add_u32 s90, s90, 32768
    s_add_u32 s91, s90, 4608
    s_add_u32 s92, s91, 4608
    s_lshl_b32 s93, s6, 12
    s_add_u32 s93, s93, 1179648
    s_mul_i32 s94, s4, 9
    s_add_u32 s94, s94, s6
    s_lshl_b32 s94, s94, 9
    s_add_u32 s94, s94, 303104
    v_lshlrev_b32 v27, 4, v0
    s_lshl_b32 s54, s6, 3
    s_add_u32 s54, s54, 18432
    v_mov_b32 v22, s54
    s_mov_b32 s86, 0xbc800000
    v_and_b32 v23, 15, v0
    v_lshlrev_b32 v23, 3, v23
    s_mov_b32 s82, 0
    s_mov_b32 s83, 0x80000000
    s_mov_b32 s84, 0x01ff01ff
    s_mov_b32 s85, 0x01ff01ff
    s_mov_b32 s53, 1048576
L_lw_53:
    ds_read_b32 v2, v1 offset:18736
    s_waitcnt lgkmcnt(0)
    v_readfirstlane_b32 s54, v2
    s_cmp_ge_u32 s54, 1
    s_cbranch_scc1 L_lwd_54
    s_sleep 1
    s_sub_u32 s53, s53, 1
    s_cmp_lg_u32 s53, 0
    s_cbranch_scc1 L_lw_53
L_lwd_54:
    s_waitcnt vmcnt(0)
    v_lshlrev_b32 v25, 16, v25
    v_mov_b32 v33, s7
    s_mov_b32 s53, 0
    buffer_load_dwordx4 v[36:39], v27, s[44:47], s93 offen offset:0 sc1
    buffer_load_dwordx4 v[40:43], v27, s[44:47], s93 offen offset:1024 sc1
    buffer_load_dwordx4 v[44:47], v27, s[44:47], s93 offen offset:2048 sc1
    buffer_load_dwordx4 v[48:51], v27, s[44:47], s93 offen offset:3072 sc1
    buffer_load_dwordx2 v[16:17], v30, s[44:47], s90 offen sc1
    buffer_load_dwordx2 v[18:19], v30, s[44:47], s91 offen sc1
    buffer_load_dwordx2 v[20:21], v30, s[44:47], s92 offen sc1
    s_branch L_gc_57
L_g_55:
    s_mov_b64 exec, s[70:71]
    s_cbranch_execz L_gs_58
    buffer_load_dwordx4 v[36:39], v27, s[44:47], s93 offen offset:0 sc1
L_gs_58:
    s_mov_b64 exec, s[72:73]
    s_cbranch_execz L_gs_59
    buffer_load_dwordx4 v[40:43], v27, s[44:47], s93 offen offset:1024 sc1
L_gs_59:
    s_mov_b64 exec, s[74:75]
    s_cbranch_execz L_gs_60
    buffer_load_dwordx4 v[44:47], v27, s[44:47], s93 offen offset:2048 sc1
L_gs_60:
    s_mov_b64 exec, s[76:77]
    s_cbranch_execz L_gs_61
    buffer_load_dwordx4 v[48:51], v27, s[44:47], s93 offen offset:3072 sc1
L_gs_61:
    s_mov_b64 exec, s[78:79]
    s_cbranch_execz L_gs_62
    buffer_load_dwordx2 v[16:17], v30, s[44:47], s90 offen sc1
L_gs_62:
    s_mov_b64 exec, s[58:59]
    s_cbranch_execz L_gs_63
    buffer_load_dwordx2 v[18:19], v30, s[44:47], s91 offen sc1
L_gs_63:
    s_mov_b64 exec, s[56:57]
    s_cbranch_execz L_gs_64
    buffer_load_dwordx2 v[20:21], v30, s[44:47], s92 offen sc1
L_gs_64:
    s_mov_b64 exec, -1
L_gc_57:
    s_waitcnt vmcnt(0)
    v_cmp_ne_u32_e64 s[70:71], s7, v39
    v_cmp_ne_u32_e64 s[72:73], s7, v43
    v_cmp_ne_u32_e64 s[74:75], s7, v47
    v_cmp_ne_u32_e64 s[76:77], s7, v51
    v_cmp_ne_u32_e64 s[78:79], s7, v17
    v_cmp_ne_u32_e64 s[58:59], s7, v19
    v_cmp_ne_u32_e64 s[56:57], s7, v21
    s_or_b64 vcc, s[70:71], s[72:73]
    s_or_b64 vcc, vcc, s[74:75]
    s_or_b64 vcc, vcc, s[76:77]
    s_or_b64 vcc, vcc, s[78:79]
    s_or_b64 vcc, vcc, s[58:59]
    s_or_b64 vcc, vcc, s[56:57]
    s_cbranch_scc0 L_gd_56
    s_add_u32 s53, s53, 1
    s_cmp_lt_u32 s53, 131072
    s_cbranch_scc1 L_g_55
L_gd_56:
    v_add_f32 v36, v36, v40
    v_add_f32 v37, v37, v41
    v_add_f32 v44, v44, v48
    v_add_f32 v45, v45, v49
    v_add_f32 v36, v36, v44
    v_add_f32 v37, v37, v45
    s_nop 1
    v_permlane32_swap_b32 v36, v37
    v_add_f32 v8, v36, v37
    v_cvt_pk_bf16_f32 v8, 0, v8
    v_mul_f32 v8, v16, v8
    v_cvt_pk_bf16_f32 v8, 0, v8
    v_add_f32 v8, v25, v8
    v_cvt_pk_bf16_f32 v8, 0, v8
    s_nop 0
    v_readfirstlane_b32 s54, v8
    s_nop 1
    v_subrev_f32 v10, s54, v8
    v_mul_f32 v11, v10, v10
    v_mov_b32 v13, s54
    v_add_f32_dpp v10, v10, v10 row_ror:8 row_mask:0xf bank_mask:0xf
    v_add_f32_dpp v11, v11, v11 row_ror:8 row_mask:0xf bank_mask:0xf
    s_nop 0
    v_add_f32_dpp v10, v10, v10 row_ror:4 row_mask:0xf bank_mask:0xf
    v_add_f32_dpp v11, v11, v11 row_ror:4 row_mask:0xf bank_mask:0xf
    s_nop 0
    v_add_f32_dpp v10, v10, v10 row_ror:2 row_mask:0xf bank_mask:0xf
    v_add_f32_dpp v11, v11, v11 row_ror:2 row_mask:0xf bank_mask:0xf
    s_nop 0
    v_add_f32_dpp v10, v10, v10 row_ror:1 row_mask:0xf bank_mask:0xf
    v_add_f32_dpp v11, v11, v11 row_ror:1 row_mask:0xf bank_mask:0xf
    s_nop 0
    v_add_f32_dpp v10, v10, v10 row_bcast:15 row_mask:0xa bank_mask:0xf
    v_add_f32_dpp v11, v11, v11 row_bcast:15 row_mask:0xa bank_mask:0xf
    s_nop 0
    v_add_f32_dpp v10, v10, v10 row_bcast:31 row_mask:0xc bank_mask:0xf
    v_add_f32_dpp v11, v11, v11 row_bcast:31 row_mask:0xc bank_mask:0xf
    v_mul_f32 v12, v10, v10
    v_fmac_f32 v13, 0x3c800000, v10
    v_fma_f32 v14, v12, s86, v11
    s_mov_b64 exec, s[82:83]
    ds_write2_b32 v22, v13, v14 offset0:0 offset1:1
    s_mov_b64 exec, -1
    v_add_f32 v24, 1.0, v20
    v_cvt_pk_bf16_f32 v24, 0, v24
    s_waitcnt lgkmcnt(0)
    s_barrier
    ds_read_b64 v[10:11], v23 offset:18432
    ds_read_b32 v12, v1 offset:18432
    s_waitcnt lgkmcnt(0)
    v_sub_f32 v10, v10, v12
    v_cndmask_b32_e64 v10, 0, v10, s[84:85]
    v_mul_f32 v13, v10, v10
    v_fmac_f32 v11, 0x42800000, v13
    v_add_f32_dpp v10, v10, v10 row_ror:8 row_mask:0xf bank_mask:0xf
    s_nop 0
    v_add_f32_dpp v11, v11, v11 row_ror:8 row_mask:0xf bank_mask:0xf
    v_add_f32_dpp v10, v10, v10 row_ror:4 row_mask:0xf bank_mask:0xf
    s_nop 0
    v_add_f32_dpp v11, v11, v11 row_ror:4 row_mask:0xf bank_mask:0xf
    v_add_f32_dpp v10, v10, v10 row_ror:2 row_mask:0xf bank_mask:0xf
    s_nop 0
    v_add_f32_dpp v11, v11, v11 row_ror:2 row_mask:0xf bank_mask:0xf
    v_add_f32_dpp v10, v10, v10 row_ror:1 row_mask:0xf bank_mask:0xf
    s_nop 0
    v_add_f32_dpp v11, v11, v11 row_ror:1 row_mask:0xf bank_mask:0xf
    v_mul_f32 v10, 0x3de38e39, v10
    v_mul_f32 v11, 0x3ae38e39, v11
    v_add_f32 v12, v12, v10
    v_fma_f32 v11, -v10, v10, v11
    v_cvt_pk_bf16_f32 v11, 0, v11
    v_cvt_pk_bf16_f32 v12, 0, v12
    v_add_f32 v11, 0x3727c5ac, v11
    v_sub_f32 v9, v8, v12
    v_cvt_pk_bf16_f32 v11, 0, v11
    v_sqrt_f32 v11, v11
    v_cvt_pk_bf16_f32 v9, 0, v9
    v_cvt_pk_bf16_f32 v11, 0, v11
    v_rcp_f32 v11, v11
    s_nop 0
    v_mul_f32 v9, v9, v11
    v_cvt_pk_bf16_f32 v9, 0, v9
    v_mul_f32 v9, v9, v24
    v_cvt_pk_bf16_f32 v9, 0, v9
    v_add_f32 v9, v9, v18
    v_cvt_pk_bf16_f32 v32, v9, v9
    buffer_store_dwordx2 v[32:33], v30, s[44:47], s94 offen
    s_add_u32 s54, s94, 524288
    buffer_store_dwordx2 v[32:33], v30, s[44:47], s54 offen sc1
    s_branch L_exit
L_wd:
    s_mov_b32 s8, s24
    s_and_b32 s9, s25, 0xffff
    s_mov_b32 s10, 4718592
    s_mov_b32 s11, 0x20000
    v_lshrrev_b32 v26, 3, v0
    v_mul_u32_u24 v26, 1152, v26
    v_lshrrev_b32 v2, 3, v0
    v_and_b32 v2, 6, v2
    v_xor_b32 v2, v2, v0
    v_and_b32 v2, 7, v2
    v_lshl_add_u32 v26, v2, 4, v26
    s_lshl_b32 s54, s6, 13
    s_add_u32 m0, s54, 86016
    s_lshl_b32 s52, s4, 3
    s_add_u32 s52, s52, s6
    s_mul_i32 s52, s52, 73728
    s_lshl_b32 s54, s5, 7
    s_add_u32 s52, s52, s54
    v_bfe_u32 v2, v0, 1, 1
    v_cmp_eq_u32 vcc, 1, v2
    v_mov_b32 v3, 0xffff
    v_mov_b32 v8, 0xffff0000
    v_cndmask_b32 v3, v3, v8, vcc
    v_bfe_u32 v2, v0, 2, 2
    v_cmp_eq_u32 vcc, 0, v2
    s_nop 1
    v_cndmask_b32 v4, 0, v3, vcc
    v_cmp_eq_u32 vcc, 1, v2
    s_nop 1
    v_cndmask_b32 v5, 0, v3, vcc
    v_cmp_eq_u32 vcc, 2, v2
    s_nop 1
    v_cndmask_b32 v6, 0, v3, vcc
    v_cmp_eq_u32 vcc, 3, v2
    s_nop 1
    v_cndmask_b32 v7, 0, v3, vcc
    v_lshrrev_b32 v28, 4, v0
    v_lshlrev_b32 v28, 3, v28
    v_and_b32 v2, 1, v0
    v_lshl_add_u32 v3, v2, 2, v28
    v_lshlrev_b32 v29, 2, v0
    v_lshlrev_b32 v30, 3, v0
    v_mov_b32 v1, 0
    v_and_b32 v2, 7, v0
    v_lshl_add_u32 v28, v2, 5, v28
    s_lshl_b32 s54, s6, 8
    v_add_u32 v28, s54, v28
    s_mov_b32 s60, 0x00ff00ff
    s_mov_b32 s61, 0x00ff00ff
    s_cmp_lg_u32 s6, 7
    s_cbranch_scc1 L_z_65
    v_mov_b32 v8, 0
    v_mov_b32 v9, 0
    ds_write_b64 v30, v[8:9] offset:18432
L_z_65:
    s_waitcnt lgkmcnt(0)
    s_mul_i32 s7, s42, 0x9e3779b5
    s_add_u32 s7, s7, 0x7f4a7c15
    s_barrier
    buffer_load_dwordx4 v26, s[8:11], s52 offen nt lds
    s_addk_i32 m0, 0x400
    s_add_u32 s52, s52, 9216
    s_waitcnt vmcnt(0)
    buffer_load_dwordx4 v26, s[8:11], s52 offen nt lds
    s_addk_i32 m0, 0x400
    s_add_u32 s52, s52, 9216
    s_waitcnt vmcnt(0)
    buffer_load_dwordx4 v26, s[8:11], s52 offen nt lds
    s_addk_i32 m0, 0x400
    s_add_u32 s52, s52, 9216
    s_waitcnt vmcnt(0)
    buffer_load_dwordx4 v26, s[8:11], s52 offen nt lds
    s_addk_i32 m0, 0x400
    s_add_u32 s52, s52, 9216
    s_waitcnt vmcnt(0)
    buffer_load_dwordx4 v26, s[8:11], s52 offen nt lds
    s_addk_i32 m0, 0x400
    s_add_u32 s52, s52, 9216
    s_waitcnt vmcnt(0)
    buffer_load_dwordx4 v26, s[8:11], s52 offen nt lds
    s_addk_i32 m0, 0x400
    s_add_u32 s52, s52, 9216
    s_waitcnt vmcnt(0)
    buffer_load_dwordx4 v26, s[8:11], s52 offen nt lds
    s_addk_i32 m0, 0x400
    s_add_u32 s52, s52, 9216
    s_waitcnt vmcnt(0)
    buffer_load_dwordx4 v26, s[8:11], s52 offen nt lds
    s_lshl_b32 s54, s6, 13
    s_add_u32 s54, s54, 86016
    v_lshrrev_b32 v8, 4, v0
    v_lshlrev_b32 v8, 10, v8
    v_bfe_u32 v2, v0, 2, 2
    v_lshl_add_u32 v8, v2, 7, v8
    v_and_b32 v2, 3, v0
    v_lshl_add_u32 v8, v2, 3, v8
    v_bfe_u32 v2, v0, 3, 1
    v_lshl_add_u32 v8, v2, 5, v8
    v_add_u32 v8, s54, v8
    v_xor_b32 v9, 32, v8
    v_xor_b32 v10, 64, v8
    v_xor_b32 v11, 0x60, v8
    s_lshl_b32 s54, s6, 7
    v_lshl_add_u32 v98, v0, 1, s54
    v_and_b32 v2, 48, v0
    v_add_u32 v99, s54, v2
    s_lshl_b32 s54, s6, 8
    v_add_u32 v97, s54, v29
    s_mov_b32 s60, 0xffff0000
    s_mov_b32 s61, 0
    s_mov_b32 s84, 0
    s_mov_b32 s85, 0xffff
    s_mov_b32 s86, 0
    s_mov_b32 s87, 0xffff0000
    s_waitcnt vmcnt(0)
    ds_read_b64_tr_b16 v[32:33], v8 offset:0
    ds_read_b64_tr_b16 v[34:35], v10 offset:512
    ds_read_b64_tr_b16 v[36:37], v9 offset:0
    ds_read_b64_tr_b16 v[38:39], v11 offset:512
    ds_read_b64_tr_b16 v[40:41], v10 offset:0
    ds_read_b64_tr_b16 v[42:43], v8 offset:512
    ds_read_b64_tr_b16 v[44:45], v11 offset:0
    ds_read_b64_tr_b16 v[46:47], v9 offset:512
    ds_read_b64_tr_b16 v[48:49], v8 offset:4096
    ds_read_b64_tr_b16 v[50:51], v10 offset:4608
    ds_read_b64_tr_b16 v[52:53], v9 offset:4096
    ds_read_b64_tr_b16 v[54:55], v11 offset:4608
    ds_read_b64_tr_b16 v[56:57], v10 offset:4096
    ds_read_b64_tr_b16 v[58:59], v8 offset:4608
    ds_read_b64_tr_b16 v[60:61], v11 offset:4096
    ds_read_b64_tr_b16 v[62:63], v9 offset:4608
    s_waitcnt lgkmcnt(0)
    s_mov_b32 s12, s32
    s_and_b32 s13, s33, 0xffff
    s_mov_b32 s14, 5308416
    s_mov_b32 s15, 0x20000
    s_mul_i32 s97, s4, 9
    s_add_u32 s97, s97, s6
    s_mul_i32 s97, s97, 73728
    s_lshl_b32 s54, s5, 7
    s_add_u32 s97, s97, s54
    s_mov_b32 s62, 0x07060501
    s_mov_b32 s63, 0x07060502
    s_mov_b32 s64, 0x07060503
    s_mov_b32 s65, 0x0c04000c
    s_lshl_b32 s90, s4, 1
    s_lshr_b32 s54, s6, 2
    s_add_u32 s90, s90, s54
    s_lshl_b32 s90, s90, 14
    s_and_b32 s54, s6, 3
    s_lshl_b32 s54, s54, 8
    s_add_u32 s90, s90, s54
    s_add_u32 s90, s90, 360448
    v_lshrrev_b32 v25, 4, v0
    v_lshlrev_b32 v25, 12, v25
    v_and_b32 v2, 15, v0
    v_lshl_add_u32 v25, v2, 4, v25
    v_bfe_u32 v24, v0, 4, 1
    v_lshlrev_b32 v24, 7, v24
    v_and_b32 v2, 1, v0
    v_lshl_add_u32 v24, v2, 6, v24
    v_lshrrev_b32 v2, 5, v0
    v_lshl_add_u32 v100, v2, 2, v24
    s_lshl_b32 s52, s5, 3
    s_add_u32 s52, s52, s4
    s_lshl_b32 s52, s52, 9
    s_add_u32 s52, s52, 1179648
    s_lshl_b32 s94, s4, 1
    s_lshr_b32 s54, s6, 2
    s_add_u32 s94, s94, s54
    s_lshl_b32 s94, s94, 11
    s_add_u32 s94, s94, 196608
    v_lshrrev_b32 v2, 2, v0
    v_and_b32 v2, 12, v2
    v_add_u32 v2, v2, v0
    v_and_b32 v2, 15, v2
    v_lshlrev_b32 v27, 7, v2
    s_mov_b32 s88, 0x3fb8aa3b
    s_bitcmp1_b32 s6, 1
    s_cselect_b32 s95, 0, 16
    s_cselect_b64 s[82:83], -1, 0
    v_and_b32 v2, 15, v0
    v_lshlrev_b32 v96, 3, v2
    v_lshrrev_b32 v2, 4, v0
    v_lshl_add_u32 v96, v2, 1, v96
    s_lshl_b32 s54, s6, 7
    v_add_u32 v96, s54, v96
    s_mov_b32 s53, 1048576
L_lw_66:
    ds_read_b32 v2, v1 offset:18736
    s_waitcnt lgkmcnt(0)
    v_readfirstlane_b32 s54, v2
    s_cmp_ge_u32 s54, 1
    s_cbranch_scc1 L_lwd_67
    s_sleep 1
    s_sub_u32 s53, s53, 1
    s_cmp_lg_u32 s53, 0
    s_cbranch_scc1 L_lw_66
L_lwd_67:
    s_mov_b32 s53, 0
    buffer_load_dwordx4 v[104:107], v27, s[44:47], s94 offen sc1
    buffer_load_dwordx4 v[8:11], v25, s[44:47], s90 offen offset:0 sc1
    buffer_load_dwordx4 v[12:15], v25, s[44:47], s90 offen offset:1024 sc1
    buffer_load_dwordx4 v[16:19], v25, s[44:47], s90 offen offset:2048 sc1
    buffer_load_dwordx4 v[20:23], v25, s[44:47], s90 offen offset:3072 sc1
    s_branch L_gc_70
L_g_68:
    s_mov_b64 exec, s[70:71]
    s_cbranch_execz L_gs_71
    buffer_load_dwordx4 v[104:107], v27, s[44:47], s94 offen sc1
L_gs_71:
    s_mov_b64 exec, s[72:73]
    s_cbranch_execz L_gs_72
    buffer_load_dwordx4 v[8:11], v25, s[44:47], s90 offen offset:0 sc1
L_gs_72:
    s_mov_b64 exec, s[74:75]
    s_cbranch_execz L_gs_73
    buffer_load_dwordx4 v[12:15], v25, s[44:47], s90 offen offset:1024 sc1
L_gs_73:
    s_mov_b64 exec, s[76:77]
    s_cbranch_execz L_gs_74
    buffer_load_dwordx4 v[16:19], v25, s[44:47], s90 offen offset:2048 sc1
L_gs_74:
    s_mov_b64 exec, s[78:79]
    s_cbranch_execz L_gs_75
    buffer_load_dwordx4 v[20:23], v25, s[44:47], s90 offen offset:3072 sc1
L_gs_75:
    s_mov_b64 exec, -1
L_gc_70:
    s_waitcnt vmcnt(0)
    v_cmp_ne_u32_e64 s[70:71], s7, v107
    v_cmp_ne_u32_e64 s[72:73], s7, v11
    v_cmp_ne_u32_e64 s[74:75], s7, v15
    v_cmp_ne_u32_e64 s[76:77], s7, v19
    v_cmp_ne_u32_e64 s[78:79], s7, v23
    s_or_b64 vcc, s[70:71], s[72:73]
    s_or_b64 vcc, vcc, s[74:75]
    s_or_b64 vcc, vcc, s[76:77]
    s_or_b64 vcc, vcc, s[78:79]
    s_cbranch_scc0 L_gd_69
    s_add_u32 s53, s53, 1
    s_cmp_eq_u32 s53, 128
    s_cselect_b32 s54, 524288, 0
    v_add_u32 v25, s54, v25
    v_add_u32 v27, s54, v27
    s_cmp_lt_u32 s53, 131072
    s_cbranch_scc1 L_g_68
L_gd_69:
    v_lshlrev_b32 v104, s95, v104
    v_and_b32 v104, 0xffff0000, v104
    v_cndmask_b32_e64 v105, v105, v106, s[82:83]
    v_mov_b32 v106, v104
    v_perm_b32 v11, v9, v8, s65
    v_lshl_or_b32 v11, v10, 24, v11
    v_max_f32_dpp v106, v106, v106 row_ror:8 row_mask:0xf bank_mask:0xf
    v_perm_b32 v15, v13, v12, s65
    v_lshl_or_b32 v15, v14, 24, v15
    v_max_f32_dpp v106, v106, v106 row_ror:4 row_mask:0xf bank_mask:0xf
    v_perm_b32 v19, v17, v16, s65
    v_lshl_or_b32 v19, v18, 24, v19
    v_max_f32_dpp v106, v106, v106 row_ror:2 row_mask:0xf bank_mask:0xf
    v_perm_b32 v23, v21, v20, s65
    v_lshl_or_b32 v23, v22, 24, v23
    v_max_f32_dpp v106, v106, v106 row_ror:1 row_mask:0xf bank_mask:0xf
    v_sub_f32 v104, v104, v106
    v_mul_f32 v104, s88, v104
    v_exp_f32 v104, v104
    s_nop 0
    v_mul_f32 v105, v105, v104
    v_mul_f32_dpp v8, v104, v8 row_newbcast:0 row_mask:0xf bank_mask:0xf
    v_mul_f32_dpp v9, v104, v9 row_newbcast:0 row_mask:0xf bank_mask:0xf
    v_mul_f32_dpp v10, v104, v10 row_newbcast:0 row_mask:0xf bank_mask:0xf
    v_mul_f32_dpp v11, v104, v11 row_newbcast:0 row_mask:0xf bank_mask:0xf
    v_add_f32_dpp v105, v105, v105 row_ror:8 row_mask:0xf bank_mask:0xf
    v_fmac_f32_dpp v8, v104, v12 row_newbcast:1 row_mask:0xf bank_mask:0xf
    v_fmac_f32_dpp v9, v104, v13 row_newbcast:1 row_mask:0xf bank_mask:0xf
    v_fmac_f32_dpp v10, v104, v14 row_newbcast:1 row_mask:0xf bank_mask:0xf
    v_fmac_f32_dpp v11, v104, v15 row_newbcast:1 row_mask:0xf bank_mask:0xf
    v_add_f32_dpp v105, v105, v105 row_ror:4 row_mask:0xf bank_mask:0xf
    v_fmac_f32_dpp v8, v104, v16 row_newbcast:2 row_mask:0xf bank_mask:0xf
    v_fmac_f32_dpp v9, v104, v17 row_newbcast:2 row_mask:0xf bank_mask:0xf
    v_fmac_f32_dpp v10, v104, v18 row_newbcast:2 row_mask:0xf bank_mask:0xf
    v_fmac_f32_dpp v11, v104, v19 row_newbcast:2 row_mask:0xf bank_mask:0xf
    v_add_f32_dpp v105, v105, v105 row_ror:2 row_mask:0xf bank_mask:0xf
    v_fmac_f32_dpp v8, v104, v20 row_newbcast:3 row_mask:0xf bank_mask:0xf
    v_fmac_f32_dpp v9, v104, v21 row_newbcast:3 row_mask:0xf bank_mask:0xf
    v_fmac_f32_dpp v10, v104, v22 row_newbcast:3 row_mask:0xf bank_mask:0xf
    v_fmac_f32_dpp v11, v104, v23 row_newbcast:3 row_mask:0xf bank_mask:0xf
    v_add_f32_dpp v105, v105, v105 row_ror:1 row_mask:0xf bank_mask:0xf
    v_rcp_f32 v105, v105
    v_permlane32_swap_b32 v8, v10
    v_permlane32_swap_b32 v9, v11
    v_add_f32 v8, v8, v10
    v_add_f32 v9, v9, v11
    s_nop 1
    v_permlane16_swap_b32 v8, v9
    v_add_f32 v8, v8, v9
    v_mul_f32 v8, v8, v105
    v_cvt_pk_bf16_f32 v23, v8, v8
    ds_write_b16 v96, v23 offset:11264
    ds_read_b128 v[100:103], v99 offset:11264
    ds_read_b128 v[104:107], v99 offset:11328
    s_waitcnt lgkmcnt(1)
    v_mfma_f32_16x16x32_bf16 v[108:111], v[100:103], v[32:35], 0
    v_mfma_f32_16x16x32_bf16 v[112:115], v[100:103], v[36:39], 0
    v_mfma_f32_16x16x32_bf16 v[116:119], v[100:103], v[40:43], 0
    v_mfma_f32_16x16x32_bf16 v[120:123], v[100:103], v[44:47], 0
    s_waitcnt lgkmcnt(0)
    v_mfma_f32_16x16x32_bf16 v[108:111], v[104:107], v[48:51], v[108:111]
    v_mfma_f32_16x16x32_bf16 v[112:115], v[104:107], v[52:55], v[112:115]
    v_mfma_f32_16x16x32_bf16 v[116:119], v[104:107], v[56:59], v[116:119]
    v_mfma_f32_16x16x32_bf16 v[120:123], v[104:107], v[60:63], v[120:123]
    v_mov_b32 v2, 1
    s_nop 4
    v_cndmask_b32_e64 v108, v108, v112, s[60:61]
    v_cndmask_b32_e64 v108, v108, v116, s[84:85]
    v_cndmask_b32_e64 v108, v108, v120, s[86:87]
    ds_write_b32 v97, v108 offset:8192
    s_mov_b64 exec, 1
    ds_add_rtn_u32 v2, v1, v2 offset:18728
    s_mov_b64 exec, -1
    ds_read2st64_b32 v[12:13], v29 offset0:32 offset1:33
    ds_read2st64_b32 v[14:15], v29 offset0:34 offset1:35
    ds_read2st64_b32 v[16:17], v29 offset0:36 offset1:37
    ds_read2st64_b32 v[18:19], v29 offset0:38 offset1:39
    s_waitcnt lgkmcnt(4)
    v_readfirstlane_b32 s54, v2
    s_cmp_lg_u32 s54, 7
    s_cbranch_scc1 L_wd_wait
    v_lshlrev_b32 v27, 4, v0
    v_mov_b32 v11, s7
    s_waitcnt lgkmcnt(3)
    v_add_f32 v8, v12, v13
    s_waitcnt lgkmcnt(2)
    v_add_f32 v14, v14, v15
    v_add_f32 v8, v8, v14
    s_waitcnt lgkmcnt(1)
    v_add_f32 v16, v16, v17
    v_add_f32 v8, v8, v16
    s_waitcnt lgkmcnt(0)
    v_add_f32 v18, v18, v19
    v_add_f32 v8, v8, v18
    v_mov_b32 v9, v8
    s_nop 1
    v_permlane32_swap_b32 v8, v9
    s_mov_b32 exec_hi, 0
    buffer_store_dwordx4 v[8:11], v27, s[44:47], s52 offen sc1
    s_mov_b64 exec, -1
    v_mov_b32 v2, 1
    ds_write_b32 v1, v2 offset:18748
    s_branch L_wd_down
L_wd_9:
    s_mov_b32 s12, s32
    s_and_b32 s13, s33, 0xffff
    s_mov_b32 s14, 5308416
    s_mov_b32 s15, 0x20000
    s_mul_i32 s97, s4, 9
    s_add_u32 s97, s97, s6
    s_mul_i32 s97, s97, 73728
    s_lshl_b32 s54, s5, 7
    s_add_u32 s97, s97, s54
    s_mov_b32 s62, 0x07060501
    s_mov_b32 s63, 0x07060502
    s_mov_b32 s64, 0x07060503
    s_mov_b32 s65, 0x0c04000c
    v_lshrrev_b32 v26, 3, v0
    v_mul_u32_u24 v26, 1152, v26
    v_lshrrev_b32 v2, 3, v0
    v_and_b32 v2, 6, v2
    v_xor_b32 v2, v2, v0
    v_and_b32 v2, 7, v2
    v_lshl_add_u32 v26, v2, 4, v26
    s_lshl_b32 s54, s6, 13
    s_add_u32 m0, s54, 86016
L_wd_wait:
    s_mov_b32 s53, 1048576
L_lw_76:
    ds_read_b32 v2, v1 offset:18748
    s_waitcnt lgkmcnt(0)
    v_readfirstlane_b32 s54, v2
    s_cmp_ge_u32 s54, 1
    s_cbranch_scc1 L_lwd_77
    s_sleep 1
    s_sub_u32 s53, s53, 1
    s_cmp_lg_u32 s53, 0
    s_cbranch_scc1 L_lw_76
L_lwd_77:
L_wd_down:
    v_lshrrev_b32 v26, 3, v0
    v_mul_u32_u24 v26, 1152, v26
    v_lshrrev_b32 v2, 3, v0
    v_and_b32 v2, 6, v2
    v_xor_b32 v2, v2, v0
    v_and_b32 v2, 7, v2
    v_lshl_add_u32 v26, v2, 4, v26
    s_lshl_b32 s54, s6, 13
    s_add_u32 m0, s54, 86016
L_wd_down1:
    s_nop 0
    buffer_load_dwordx4 v26, s[12:15], s97 offen nt lds
    s_addk_i32 m0, 0x400
    s_add_u32 s97, s97, 9216
    buffer_load_dwordx4 v26, s[12:15], s97 offen nt lds
    s_addk_i32 m0, 0x400
    s_add_u32 s97, s97, 9216
    buffer_load_dwordx4 v26, s[12:15], s97 offen nt lds
    s_addk_i32 m0, 0x400
    s_add_u32 s97, s97, 9216
    buffer_load_dwordx4 v26, s[12:15], s97 offen nt lds
    s_addk_i32 m0, 0x400
    s_add_u32 s97, s97, 9216
    buffer_load_dwordx4 v26, s[12:15], s97 offen nt lds
    s_addk_i32 m0, 0x400
    s_add_u32 s97, s97, 9216
    buffer_load_dwordx4 v26, s[12:15], s97 offen nt lds
    s_addk_i32 m0, 0x400
    s_add_u32 s97, s97, 9216
    buffer_load_dwordx4 v26, s[12:15], s97 offen nt lds
    s_addk_i32 m0, 0x400
    s_add_u32 s97, s97, 9216
    buffer_load_dwordx4 v26, s[12:15], s97 offen nt lds
L_wd_down2:
    s_mul_i32 s90, s4, 9216
    s_lshl_b32 s54, s6, 9
    s_add_u32 s90, s90, s54
    s_add_u32 s90, s90, 229376
    s_add_u32 s91, s90, 4608
    s_lshl_b32 s52, s5, 3
    s_add_u32 s52, s52, s4
    s_lshl_b32 s52, s52, 9
    s_add_u32 s52, s52, 1245184
    v_mov_b32 v25, v30
    s_mov_b32 s92, 0x3d372713
    s_lshl_b32 s54, s6, 13
    s_add_u32 s54, s54, 86016
    v_lshrrev_b32 v8, 4, v0
    v_lshlrev_b32 v8, 10, v8
    v_bfe_u32 v2, v0, 2, 2
    v_lshl_add_u32 v8, v2, 7, v8
    v_and_b32 v2, 3, v0
    v_lshl_add_u32 v8, v2, 3, v8
    v_bfe_u32 v2, v0, 3, 1
    v_lshl_add_u32 v8, v2, 5, v8
    v_add_u32 v8, s54, v8
    v_xor_b32 v9, 32, v8
    v_xor_b32 v10, 64, v8
    v_xor_b32 v11, 0x60, v8
    s_lshl_b32 s54, s6, 7
    v_lshl_add_u32 v98, v0, 1, s54
    v_and_b32 v2, 48, v0
    v_add_u32 v99, s54, v2
    s_lshl_b32 s54, s6, 8
    v_add_u32 v97, s54, v29
    s_mov_b32 s60, 0xffff0000
    s_mov_b32 s61, 0
    s_mov_b32 s84, 0
    s_mov_b32 s85, 0xffff
    s_mov_b32 s86, 0
    s_mov_b32 s87, 0xffff0000
    s_waitcnt vmcnt(0)
    ds_read_b64_tr_b16 v[64:65], v8 offset:0
    ds_read_b64_tr_b16 v[66:67], v10 offset:512
    ds_read_b64_tr_b16 v[68:69], v9 offset:0
    ds_read_b64_tr_b16 v[70:71], v11 offset:512
    ds_read_b64_tr_b16 v[72:73], v10 offset:0
    ds_read_b64_tr_b16 v[74:75], v8 offset:512
    ds_read_b64_tr_b16 v[76:77], v11 offset:0
    ds_read_b64_tr_b16 v[78:79], v9 offset:512
    ds_read_b64_tr_b16 v[80:81], v8 offset:4096
    ds_read_b64_tr_b16 v[82:83], v10 offset:4608
    ds_read_b64_tr_b16 v[84:85], v9 offset:4096
    ds_read_b64_tr_b16 v[86:87], v11 offset:4608
    ds_read_b64_tr_b16 v[88:89], v10 offset:4096
    ds_read_b64_tr_b16 v[90:91], v8 offset:4608
    ds_read_b64_tr_b16 v[92:93], v11 offset:4096
    ds_read_b64_tr_b16 v[94:95], v9 offset:4608
    s_waitcnt lgkmcnt(0)
    s_mov_b32 s53, 0
    buffer_load_dwordx2 v[8:9], v25, s[44:47], s90 offen sc1
    buffer_load_dwordx2 v[10:11], v25, s[44:47], s91 offen sc1
    s_branch L_gc_80
L_g_78:
    s_mov_b64 exec, s[70:71]
    s_cbranch_execz L_gs_81
    buffer_load_dwordx2 v[8:9], v25, s[44:47], s90 offen sc1
L_gs_81:
    s_mov_b64 exec, s[72:73]
    s_cbranch_execz L_gs_82
    buffer_load_dwordx2 v[10:11], v25, s[44:47], s91 offen sc1
L_gs_82:
    s_mov_b64 exec, -1
L_gc_80:
    s_waitcnt vmcnt(0)
    v_cmp_ne_u32_e64 s[70:71], s7, v9
    v_cmp_ne_u32_e64 s[72:73], s7, v11
    s_or_b64 vcc, s[70:71], s[72:73]
    s_cbranch_scc0 L_gd_79
    s_add_u32 s53, s53, 1
    s_cmp_eq_u32 s53, 128
    s_cselect_b32 s54, 524288, 0
    v_add_u32 v25, s54, v25
    s_cmp_lt_u32 s53, 131072
    s_cbranch_scc1 L_g_78
L_gd_79:
    v_mul_f32 v12, v8, v8
    v_fma_f32 v12, v12, s92, 1.0
    v_mul_f32 v12, v12, v8
    v_mul_f32 v12, 0xc0135761, v12
    v_exp_f32 v12, v12
    s_nop 0
    v_add_f32 v12, 1.0, v12
    v_rcp_f32 v12, v12
    s_nop 0
    v_mul_f32 v12, v12, v8
    v_cvt_pk_bf16_f32 v12, 0, v12
    v_mul_f32 v12, v12, v10
    v_cvt_pk_bf16_f32 v23, v12, v12
    ds_write_b16 v98, v23 offset:11264
    ds_read_b128 v[100:103], v99 offset:11264
    ds_read_b128 v[104:107], v99 offset:11328
    s_waitcnt lgkmcnt(1)
    v_mfma_f32_16x16x32_bf16 v[108:111], v[100:103], v[64:67], 0
    v_mfma_f32_16x16x32_bf16 v[112:115], v[100:103], v[68:71], 0
    v_mfma_f32_16x16x32_bf16 v[116:119], v[100:103], v[72:75], 0
    v_mfma_f32_16x16x32_bf16 v[120:123], v[100:103], v[76:79], 0
    s_waitcnt lgkmcnt(0)
    v_mfma_f32_16x16x32_bf16 v[108:111], v[104:107], v[80:83], v[108:111]
    v_mfma_f32_16x16x32_bf16 v[112:115], v[104:107], v[84:87], v[112:115]
    v_mfma_f32_16x16x32_bf16 v[116:119], v[104:107], v[88:91], v[116:119]
    v_mfma_f32_16x16x32_bf16 v[120:123], v[104:107], v[92:95], v[120:123]
    v_mov_b32 v2, 1
    s_nop 4
    v_cndmask_b32_e64 v108, v108, v112, s[60:61]
    v_cndmask_b32_e64 v108, v108, v116, s[84:85]
    v_cndmask_b32_e64 v108, v108, v120, s[86:87]
    ds_write_b32 v97, v108 offset:13312
    s_mov_b64 exec, 1
    ds_add_rtn_u32 v2, v1, v2 offset:18732
    s_mov_b64 exec, -1
    ds_read2st64_b32 v[12:13], v29 offset0:52 offset1:53
    ds_read2st64_b32 v[14:15], v29 offset0:54 offset1:55
    ds_read2st64_b32 v[16:17], v29 offset0:56 offset1:57
    ds_read2st64_b32 v[18:19], v29 offset0:58 offset1:59
    ds_read_b32 v20, v29 offset:15360
    s_waitcnt lgkmcnt(5)
    v_readfirstlane_b32 s54, v2
    s_cmp_lg_u32 s54, 8
    s_cbranch_scc1 L_exit
    v_lshlrev_b32 v27, 4, v0
    v_mov_b32 v11, s7
    s_waitcnt lgkmcnt(4)
    v_add_f32 v8, v12, v13
    s_waitcnt lgkmcnt(3)
    v_add_f32 v14, v14, v15
    v_add_f32 v8, v8, v14
    s_waitcnt lgkmcnt(2)
    v_add_f32 v16, v16, v17
    v_add_f32 v8, v8, v16
    s_waitcnt lgkmcnt(1)
    v_add_f32 v18, v18, v19
    v_add_f32 v8, v8, v18
    s_waitcnt lgkmcnt(0)
    v_add_f32 v8, v8, v20
    v_mov_b32 v9, v8
    s_nop 1
    v_permlane32_swap_b32 v8, v9
    s_mov_b32 exec_hi, 0
    buffer_store_dwordx4 v[8:11], v27, s[44:47], s52 offen sc1
    s_mov_b64 exec, -1
L_exit:
L_end:
    s_endpgm
L_code_end:
.section .rodata,"a"
.p2align 6
.amdhsa_kernel adaLN_cond__sliding_block_cached__glu_gated_geglu__decode_kernel
  .amdhsa_next_free_vgpr 128
  .amdhsa_next_free_sgpr 102
  .amdhsa_accum_offset 128
  .amdhsa_group_segment_fixed_size 0
  .amdhsa_kernarg_size 112
  .amdhsa_user_sgpr_count 2
  .amdhsa_user_sgpr_kernarg_segment_ptr 1
  .amdhsa_system_sgpr_workgroup_id_x 1
.end_amdhsa_kernel
```
